```python
import torch

def _softmax(x, axis=-1):
    return torch.softmax(x, dim=axis)
def _gelu(x):
    return torch.nn.functional.gelu(x, approximate="tanh")
def _silu(x):
    return torch.nn.functional.silu(x)
def _sigmoid(x):
    return torch.sigmoid(x)
def _layernorm(x, axis=-1, eps=1e-5):
    m = x.mean(dim=axis, keepdim=True)
    v = x.var(dim=axis, keepdim=True, unbiased=False)
    return (x - m) / torch.sqrt(v + eps)
def _scatter_add(tgt, idx, src, axis=0):
    return tgt.clone().index_add_(axis, idx, src)
def _segment_sum(src, seg, n):
    out = torch.zeros((n,) + src.shape[1:], dtype=src.dtype)
    return out.index_add_(0, seg, src)
def _pad(x, pw):
    flat = tuple(v for pair in reversed(pw) for v in pair)
    return torch.nn.functional.pad(x, flat)

kernel_name = 'concat_heads__gqa_block_cached__gqa_block_cached__near_ridge'

def setup_inputs():

    _w = (lambda a: (lambda t: t.to(torch.bfloat16) if t.is_floating_point() else t)(torch.as_tensor(a)))
    def _A_setup():
        B, Sq, D = 8, 144, 640
        Hq, Hkv, Sk, Dh = 32, 32, 512, 192
        assert Hq % Hkv == 0, (Hq, Hkv)
        return {
            "x": _w((lambda *s: torch.randn(*s, dtype=torch.bfloat16) * 0.8)(B, Sq, D)),
            "k_cache": _w((lambda *s: torch.randn(*s, dtype=torch.bfloat16) * 0.8)(B, Hkv, Sk, Dh)),
            "v_cache": _w((lambda *s: torch.randn(*s, dtype=torch.bfloat16) * 0.05)(B, Hkv, Sk, Dh)),
            "wq": _w((lambda *s: torch.randn(*s, dtype=torch.bfloat16) * 0.8)(D, Hq * Dh) * (D ** -0.5)),
            "wo": _w((lambda *s: torch.randn(*s, dtype=torch.bfloat16) * 0.05)(Hq * Dh, D) * ((Hq * Dh) ** -0.5)),
        }
    _A_in = _A_setup()

    def _B_setup():
        B, Sq, D = 8, 144, 640
        Hq, Hkv, Sk, Dh = 32, 32, 512, 192
        assert Hq % Hkv == 0, (Hq, Hkv)
        return {
            "x": _w((lambda *s: torch.randn(*s, dtype=torch.bfloat16) * 0.8)(B, Sq, D)),
            "k_cache": _w((lambda *s: torch.randn(*s, dtype=torch.bfloat16) * 0.8)(B, Hkv, Sk, Dh)),
            "v_cache": _w((lambda *s: torch.randn(*s, dtype=torch.bfloat16) * 0.05)(B, Hkv, Sk, Dh)),
            "wq": _w((lambda *s: torch.randn(*s, dtype=torch.bfloat16) * 0.8)(D, Hq * Dh) * (D ** -0.5)),
            "wo": _w((lambda *s: torch.randn(*s, dtype=torch.bfloat16) * 0.05)(Hq * Dh, D) * ((Hq * Dh) ** -0.5)),
        }
    _B_in = _B_setup()

    return {
        "A_x": _A_in["x"],
        "A_k_cache": _A_in["k_cache"],
        "A_v_cache": _A_in["v_cache"],
        "A_wq": _A_in["wq"],
        "A_wo": _A_in["wo"],
        "B_x": _B_in["x"],
        "B_k_cache": _B_in["k_cache"],
        "B_v_cache": _B_in["v_cache"],
        "B_wq": _B_in["wq"],
        "B_wo": _B_in["wo"],
    }

def reference(A_x, A_k_cache, A_v_cache, A_wq, A_wo, B_x, B_k_cache, B_v_cache, B_wq, B_wo):
    def _A_ref(x, k_cache, v_cache, wq, wo):
        B, Sq, D = x.shape
        Hq, Dh = 32, 192
        Hkv = k_cache.shape[1]
        rep = Hq // Hkv
        q = (lambda x, *d: x.permute(*d))((x @ wq).reshape(B, Sq, Hq, Dh), 0, 2, 1, 3)
        k = (lambda x, n, axis: torch.repeat_interleave(x, n, dim=axis))(k_cache, rep, axis=1)
        v = (lambda x, n, axis: torch.repeat_interleave(x, n, dim=axis))(v_cache, rep, axis=1)
        scores = torch.einsum("bhqd,bhkd->bhqk", q, k) * (Dh ** -0.5)
        p = _softmax(scores, axis=-1)
        o = torch.einsum("bhqk,bhkd->bhqd", p, v)
        return (lambda x, *d: x.permute(*d))(o, 0, 2, 1, 3).reshape(B, Sq, Hq * Dh) @ wo

    def _B_ref(x, k_cache, v_cache, wq, wo):
        B, Sq, D = x.shape
        Hq, Dh = 32, 192
        Hkv = k_cache.shape[1]
        rep = Hq // Hkv
        q = (lambda x, *d: x.permute(*d))((x @ wq).reshape(B, Sq, Hq, Dh), 0, 2, 1, 3)
        k = (lambda x, n, axis: torch.repeat_interleave(x, n, dim=axis))(k_cache, rep, axis=1)
        v = (lambda x, n, axis: torch.repeat_interleave(x, n, dim=axis))(v_cache, rep, axis=1)
        scores = torch.einsum("bhqd,bhkd->bhqk", q, k) * (Dh ** -0.5)
        p = _softmax(scores, axis=-1)
        o = torch.einsum("bhqk,bhkd->bhqd", p, v)
        return (lambda x, *d: x.permute(*d))(o, 0, 2, 1, 3).reshape(B, Sq, Hq * Dh) @ wo

    a = _A_ref(A_x, A_k_cache, A_v_cache, A_wq, A_wo)
    b = _B_ref(B_x, B_k_cache, B_v_cache, B_wq, B_wo)
    return torch.concatenate([a, b], axis=-1)
```

```asm
; @launch kernel=concat_heads__gqa_block_cached__gqa_block_cached__near_ridge_kernel grid=(256,1,1) block=(256,1,1) lds=160768
; @launch kernel=reduce_kernel grid=(720,1,1) block=(256,1,1) lds=0
.amdgcn_target "amdgcn-amd-amdhsa--gfx950"
.text
.globl concat_heads__gqa_block_cached__gqa_block_cached__near_ridge_kernel
.p2align 8
.type concat_heads__gqa_block_cached__gqa_block_cached__near_ridge_kernel,@function
concat_heads__gqa_block_cached__gqa_block_cached__near_ridge_kernel:
  s_cmp_ge_u32 s2, 256
  s_cbranch_scc1 K1END
  s_and_b32 s3, s2, 4
  s_mul_i32 s3, s3, 10
  s_add_u32 s60, s0, s3
  s_addc_u32 s61, s1, 0
  s_load_dwordx4 s[64:67], s[60:61], 0
  s_load_dwordx4 s[68:71], s[60:61], 16
  s_load_dwordx2 s[72:73], s[60:61], 32
  s_load_dwordx2 s[74:75], s[0:1], 96
  s_load_dwordx4 s[96:99], s[0:1], 80
  s_getpc_b64 s[62:63]
  v_lshlrev_b32 v16, 4, v0
  global_load_dword v252, v16, s[62:63]
  v_add_u32 v16, 0x1000, v16
  global_load_dword v252, v16, s[62:63]
  v_add_u32 v16, 0x1000, v16
  global_load_dword v252, v16, s[62:63]
  v_add_u32 v16, 0x1000, v16
  global_load_dword v252, v16, s[62:63]
  v_add_u32 v16, 0x1000, v16
  global_load_dword v252, v16, s[62:63]
  v_add_u32 v16, 0x1000, v16
  global_load_dword v252, v16, s[62:63]
  v_add_u32 v16, 0x1000, v16
  global_load_dword v252, v16, s[62:63]
  v_add_u32 v16, 0x1000, v16
  global_load_dword v252, v16, s[62:63]
  v_add_u32 v16, 0x1000, v16
  global_load_dword v252, v16, s[62:63]
  v_add_u32 v16, 0x1000, v16
  v_lshrrev_b32 v1, 6, v0
  s_nop 0
  v_readfirstlane_b32 s36, v1
  s_mov_b32 s52, 0xa72ee0
  s_lshr_b32 s57, s2, 3
  s_and_b32 s58, s57, 7
  s_lshr_b32 s57, s57, 3
  s_and_b32 s59, s2, 3
  s_lshl_b32 s59, s59, 2
  s_add_u32 s59, s59, s57
  s_mul_i32 s37, s36, 6144
  v_and_b32 v2, 63, v0
  v_lshrrev_b32 v1, 6, v0
  v_lshrrev_b32 v3, 3, v2
  v_mad_u32_u24 v3, v1, 48, v3
  v_add_u32 v3, 0, v3
  v_bfe_u32 v4, v3, 1, 3
  v_mul_u32_u24 v4, 3, v4
  v_bfe_u32 v4, s52, v4, 3
  v_and_b32 v5, 7, v2
  v_xor_b32 v4, v4, v5
  v_mul_u32_u24 v3, 0x500, v3
  v_lshl_add_u32 v198, v4, 4, v3
  v_lshrrev_b32 v3, 3, v2
  v_mad_u32_u24 v3, v1, 48, v3
  v_add_u32 v3, 8, v3
  v_bfe_u32 v4, v3, 1, 3
  v_mul_u32_u24 v4, 3, v4
  v_bfe_u32 v4, s52, v4, 3
  v_and_b32 v5, 7, v2
  v_xor_b32 v4, v4, v5
  v_mul_u32_u24 v3, 0x500, v3
  v_lshl_add_u32 v199, v4, 4, v3
  v_add_u32 v199, 0xfffffc00, v199
  v_add_u32 v240, 0x4800, v198
  v_add_u32 v241, 0x5400, v199
  v_add_u32 v242, 0x9c00, v198
  v_add_u32 v243, 0x9c00, v199
  v_mul_u32_u24 v6, 0x180, v1
  v_add_u32 v6, v6, v2
  v_add_u32 v3, 0, v6
  v_mul_u32_u24 v4, 0xaab, v3
  v_lshrrev_b32 v4, 16, v4
  v_mul_u32_u24 v5, 24, v4
  v_sub_u32 v3, v3, v5
  v_bfe_u32 v5, v4, 1, 3
  v_mul_u32_u24 v5, 3, v5
  v_bfe_u32 v5, s52, v5, 3
  v_xor_b32 v3, v3, v5
  v_mul_u32_u24 v5, 0x3000, v4
  v_lshl_add_u32 v192, v3, 4, v5
  v_mul_u32_u24 v5, 0x180, v4
  v_lshl_add_u32 v10, v3, 4, v5
  v_add_u32 v3, 64, v6
  v_mul_u32_u24 v4, 0xaab, v3
  v_lshrrev_b32 v4, 16, v4
  v_mul_u32_u24 v5, 24, v4
  v_sub_u32 v3, v3, v5
  v_bfe_u32 v5, v4, 1, 3
  v_mul_u32_u24 v5, 3, v5
  v_bfe_u32 v5, s52, v5, 3
  v_xor_b32 v3, v3, v5
  v_add_u32 v3, 0xffffffc0, v3
  v_mul_u32_u24 v5, 0x3000, v4
  v_lshl_add_u32 v193, v3, 4, v5
  v_mul_u32_u24 v5, 0x180, v4
  v_lshl_add_u32 v11, v3, 4, v5
  v_add_u32 v3, 0x80, v6
  v_mul_u32_u24 v4, 0xaab, v3
  v_lshrrev_b32 v4, 16, v4
  v_mul_u32_u24 v5, 24, v4
  v_sub_u32 v3, v3, v5
  v_bfe_u32 v5, v4, 1, 3
  v_mul_u32_u24 v5, 3, v5
  v_bfe_u32 v5, s52, v5, 3
  v_xor_b32 v3, v3, v5
  v_add_u32 v3, 0xffffff80, v3
  v_mul_u32_u24 v5, 0x3000, v4
  v_lshl_add_u32 v194, v3, 4, v5
  v_mul_u32_u24 v5, 0x180, v4
  v_lshl_add_u32 v12, v3, 4, v5
  v_add_u32 v3, 0xc0, v6
  v_mul_u32_u24 v4, 0xaab, v3
  v_lshrrev_b32 v4, 16, v4
  v_mul_u32_u24 v5, 24, v4
  v_sub_u32 v3, v3, v5
  v_bfe_u32 v5, v4, 1, 3
  v_mul_u32_u24 v5, 3, v5
  v_bfe_u32 v5, s52, v5, 3
  v_xor_b32 v3, v3, v5
  v_mul_u32_u24 v5, 0x3000, v4
  v_lshl_add_u32 v195, v3, 4, v5
  v_mul_u32_u24 v5, 0x180, v4
  v_lshl_add_u32 v13, v3, 4, v5
  v_add_u32 v3, 0x100, v6
  v_mul_u32_u24 v4, 0xaab, v3
  v_lshrrev_b32 v4, 16, v4
  v_mul_u32_u24 v5, 24, v4
  v_sub_u32 v3, v3, v5
  v_bfe_u32 v5, v4, 1, 3
  v_mul_u32_u24 v5, 3, v5
  v_bfe_u32 v5, s52, v5, 3
  v_xor_b32 v3, v3, v5
  v_add_u32 v3, 0xffffffc0, v3
  v_mul_u32_u24 v5, 0x3000, v4
  v_lshl_add_u32 v196, v3, 4, v5
  v_mul_u32_u24 v5, 0x180, v4
  v_lshl_add_u32 v14, v3, 4, v5
  v_add_u32 v3, 0x140, v6
  v_mul_u32_u24 v4, 0xaab, v3
  v_lshrrev_b32 v4, 16, v4
  v_mul_u32_u24 v5, 24, v4
  v_sub_u32 v3, v3, v5
  v_bfe_u32 v5, v4, 1, 3
  v_mul_u32_u24 v5, 3, v5
  v_bfe_u32 v5, s52, v5, 3
  v_xor_b32 v3, v3, v5
  v_add_u32 v3, 0xffffff80, v3
  v_mul_u32_u24 v5, 0x3000, v4
  v_lshl_add_u32 v197, v3, 4, v5
  v_mul_u32_u24 v5, 0x180, v4
  v_lshl_add_u32 v15, v3, 4, v5
  s_waitcnt lgkmcnt(0)
  s_mul_i32 s3, s58, 184320
  s_add_u32 s4, s64, s3
  s_addc_u32 s5, s65, 0
  s_mov_b32 s6, 184320
  s_mov_b32 s7, 0x20000
  s_mul_i32 s3, s59, 768
  s_add_u32 s8, s70, s3
  s_addc_u32 s9, s71, 0
  s_mov_b32 s10, 7864320
  s_mov_b32 s11, 0x20000
  s_sub_u32 s10, s10, s3
  s_mov_b32 s56, 0
  s_mov_b32 s43, 0
  s_mov_b32 s44, 384
  s_add_u32 m0, s37, 0
  s_nop 0
  buffer_load_dwordx4 v198, s[4:7], s56 offen offset:0 nt lds
  buffer_load_dwordx4 v199, s[4:7], s56 offen offset:1024 nt lds
  buffer_load_dwordx4 v240, s[4:7], s56 offen offset:2048 nt lds
  s_add_u32 m0, s37, 3072
  s_nop 0
  buffer_load_dwordx4 v241, s[4:7], s56 offen offset:0 nt lds
  buffer_load_dwordx4 v242, s[4:7], s56 offen offset:1024 nt lds
  buffer_load_dwordx4 v243, s[4:7], s56 offen offset:2048 nt lds
  s_add_u32 m0, s37, 24576
  s_nop 0
  buffer_load_dwordx4 v192, s[8:11], s43 offen offset:0 nt lds
  buffer_load_dwordx4 v193, s[8:11], s43 offen offset:1024 nt lds
  buffer_load_dwordx4 v194, s[8:11], s43 offen offset:2048 nt lds
  s_add_u32 m0, s37, 27648
  s_nop 0
  buffer_load_dwordx4 v195, s[8:11], s43 offen offset:0 nt lds
  buffer_load_dwordx4 v196, s[8:11], s43 offen offset:1024 nt lds
  buffer_load_dwordx4 v197, s[8:11], s43 offen offset:2048 nt lds
  v_accvgpr_write_b32 a120, 0
  v_accvgpr_write_b32 a121, 0
  v_accvgpr_write_b32 a122, 0
  v_accvgpr_write_b32 a123, 0
  s_add_u32 m0, s37, 49152
  s_nop 0
  buffer_load_dwordx4 v192, s[8:11], s44 offen offset:0 nt lds
  v_mfma_f32_32x32x16_bf16 v[32:47], a[120:123], a[120:123], 0
  s_lshl_b32 s76, s58, 4
  s_add_u32 s76, s76, s59
  s_lshl_b32 s77, s76, 1
  s_mul_i32 s3, s77, 196608
  s_add_u32 s12, s66, s3
  s_addc_u32 s13, s67, 0
  s_mov_b32 s14, 393216
  s_mov_b32 s15, 0x20000
  s_mul_i32 s3, s77, 196608
  s_add_u32 s16, s68, s3
  s_addc_u32 s17, s69, 0
  s_mov_b32 s18, 393216
  s_mov_b32 s19, 0x20000
  buffer_load_dwordx4 v193, s[8:11], s44 offen offset:1024 nt lds
  buffer_load_dwordx4 v194, s[8:11], s44 offen offset:2048 nt lds
  v_mfma_f32_32x32x16_bf16 v[48:63], a[120:123], a[120:123], 0
  s_mul_i32 s3, s59, 491520
  s_add_u32 s20, s72, s3
  s_addc_u32 s21, s73, 0
  s_mov_b32 s22, 491520
  s_mov_b32 s23, 0x20000
  s_and_b32 s3, s2, 4
  s_lshl_b32 s3, s3, 5
  s_add_u32 s76, s76, s3
  s_mul_i32 s3, s76, 184320
  s_add_u32 s24, s74, s3
  s_addc_u32 s25, s75, 0
  s_mov_b32 s26, 184320
  s_mov_b32 s27, 0x20000
  s_mov_b32 s28, s12
  s_add_u32 m0, s37, 52224
  s_nop 0
  buffer_load_dwordx4 v195, s[8:11], s44 offen offset:0 nt lds
  v_mfma_f32_32x32x16_bf16 v[64:79], a[120:123], a[120:123], 0
  s_mov_b32 s29, s13
  s_mov_b32 s30, s14
  s_mov_b32 s31, 0x20000
  s_mov_b32 s32, s12
  s_mov_b32 s33, s13
  s_mov_b32 s34, s14
  s_mov_b32 s35, 0x20000
  s_mov_b32 s47, 0x3dd53b95
  s_mov_b32 s48, 0x4299ac27
  s_mov_b32 s40, 73728
  s_mov_b64 vcc, 0
  s_mov_b32 s45, 0
  s_mov_b32 s54, 0
  buffer_load_dwordx4 v196, s[8:11], s44 offen offset:1024 nt lds
  buffer_load_dwordx4 v197, s[8:11], s44 offen offset:2048 nt lds
  v_mfma_f32_32x32x16_bf16 v[80:95], a[120:123], a[120:123], 0
  s_mov_b32 s55, 0
  v_accvgpr_write_b32 a144, v10
  v_accvgpr_write_b32 a145, v11
  v_accvgpr_write_b32 a146, v12
  v_accvgpr_write_b32 a147, v13
  v_accvgpr_write_b32 a148, v14
  v_accvgpr_write_b32 a149, v15
  v_bfe_u32 v3, v2, 2, 2
  v_and_b32 v4, 3, v2
  v_lshrrev_b32 v5, 5, v2
  v_bfe_u32 v6, v2, 4, 1
  v_lshrrev_b32 v7, 4, v2
  v_and_b32 v8, 2, v3
  v_lshlrev_b32 v8, 1, v8
  s_mov_b32 s56, 128
  s_mov_b32 s43, 786432
  v_mfma_f32_32x32x16_bf16 v[96:111], a[120:123], a[120:123], 0
  v_and_b32 v9, 15, v2
  v_and_b32 v10, 31, v2
  v_and_b32 v11, 1, v4
  v_lshrrev_b32 v12, 1, v4
  v_lshl_add_u32 v13, v5, 3, v3
  v_lshl_add_u32 v14, v6, 1, v11
  v_lshl_or_b32 v15, v5, 1, v8
  v_xor_b32 v14, v14, v15
  v_mul_u32_u24 v238, 0x180, v13
  v_lshl_add_u32 v238, v14, 4, v238
  v_lshl_add_u32 v238, v12, 3, v238
  v_lshl_add_u32 v13, v7, 3, v3
  v_lshl_add_u32 v14, v1, 1, v12
  v_lshl_or_b32 v15, v6, 1, v8
  s_add_u32 m0, s37, 73728
  s_nop 0
  buffer_load_dwordx4 v198, s[4:7], s56 offen offset:0 nt lds
  v_mfma_f32_32x32x16_bf16 v[112:127], a[120:123], a[120:123], 0
  v_xor_b32 v14, v14, v15
  v_mul_u32_u24 v213, 0x180, v13
  v_lshl_add_u32 v213, v14, 4, v213
  v_lshl_add_u32 v213, v11, 3, v213
  v_lshl_add_u32 v14, v1, 2, v4
  v_lshlrev_b32 v15, 1, v3
  v_lshl_or_b32 v15, v6, 3, v15
  v_xor_b32 v14, v14, v15
  v_mul_u32_u24 v17, 0x100, v13
  v_lshl_add_u32 v17, v14, 4, v17
  v_accvgpr_write_b32 a175, v17
  v_lshl_add_u32 v13, v5, 2, v3
  v_lshl_add_u32 v14, v6, 1, v12
  buffer_load_dwordx4 v199, s[4:7], s56 offen offset:1024 nt lds
  buffer_load_dwordx4 v240, s[4:7], s56 offen offset:2048 nt lds
  v_mfma_f32_32x32x16_bf16 v[128:143], a[120:123], a[120:123], 0
  v_mul_u32_u24 v15, 3, v5
  v_or_b32 v15, v15, v8
  v_xor_b32 v14, v14, v15
  v_mul_u32_u24 v212, 0x180, v13
  v_lshl_add_u32 v212, v14, 4, v212
  v_lshl_add_u32 v212, v11, 3, v212
  v_lshl_add_u32 v14, v11, 3, v6
  v_lshlrev_b32 v15, 1, v3
  v_xor_b32 v14, v14, v15
  v_mul_u32_u24 v17, 0x100, v13
  v_lshl_add_u32 v17, v14, 4, v17
  v_lshl_add_u32 v17, v12, 3, v17
  v_accvgpr_write_b32 a174, v17
  v_bfe_u32 v14, v10, 1, 3
  s_add_u32 m0, s37, 76800
  s_nop 0
  buffer_load_dwordx4 v241, s[4:7], s56 offen offset:0 nt lds
  v_mfma_f32_32x32x16_bf16 v[144:159], a[120:123], a[120:123], 0
  v_mul_u32_u24 v14, 3, v14
  v_bfe_u32 v14, s52, v14, 3
  v_xor_b32 v14, v14, v5
  v_mul_u32_u24 v210, 0x180, v10
  v_lshl_add_u32 v210, v14, 4, v210
  v_lshl_add_u32 v13, v1, 5, v10
  v_mul_u32_u24 v236, 0x80, v13
  v_lshl_add_u32 v236, v14, 4, v236
  v_bfe_u32 v15, v9, 1, 3
  v_mul_u32_u24 v15, 3, v15
  v_bfe_u32 v15, s52, v15, 3
  v_xor_b32 v14, v15, v7
  v_lshl_add_u32 v13, v1, 4, v9
  v_mul_u32_u24 v211, 0x180, v13
  buffer_load_dwordx4 v242, s[4:7], s56 offen offset:1024 nt lds
  buffer_load_dwordx4 v243, s[4:7], s56 offen offset:2048 nt lds
  v_mfma_f32_32x32x16_bf16 v[160:175], a[120:123], a[120:123], 0
  v_lshl_add_u32 v211, v14, 4, v211
  v_mul_u32_u24 v237, 0x80, v9
  v_lshl_add_u32 v237, v14, 4, v237
  v_add_u32 v237, 0x4000, v237
  v_mul_u32_u24 v227, 0x180, v9
  v_lshl_add_u32 v227, v14, 4, v227
  v_add_u32 v227, 0x24000, v227
  v_mul_u32_u24 v223, 0x80, v9
  v_lshl_add_u32 v223, v14, 4, v223
  v_add_u32 v223, 0x24000, v223
  v_lshl_add_u32 v14, v1, 1, v5
  v_xor_b32 v14, v14, v15
  v_mul_u32_u24 v226, 0x180, v9
  s_add_u32 m0, s37, 98304
  s_nop 0
  buffer_load_dwordx4 v192, s[8:11], s43 offen offset:0 nt lds
  v_mfma_f32_32x32x16_bf16 v[176:191], a[120:123], a[120:123], 0
  v_lshl_add_u32 v226, v14, 4, v226
  v_lshl_add_u32 v226, v6, 3, v226
  v_add_u32 v226, 0x24000, v226
  v_mul_u32_u24 v222, 0x80, v9
  v_lshl_add_u32 v222, v14, 4, v222
  v_lshl_add_u32 v222, v6, 3, v222
  v_add_u32 v222, 0x24000, v222
  v_lshlrev_b32 v225, 4, v9
  v_add_u32 v225, 0x27000, v225
  v_lshl_add_u32 v224, v1, 2, v225
  v_lshlrev_b32 v13, 4, v2
  v_lshl_add_u32 v248, v1, 13, v13
  v_lshl_add_u32 v13, v1, 10, v13
  v_add_u32 v249, 0x7000, v13
  buffer_load_dwordx4 v193, s[8:11], s43 offen offset:1024 nt lds
  buffer_load_dwordx4 v194, s[8:11], s43 offen offset:2048 nt lds
  v_mfma_f32_16x16x32_bf16 a[150:153], a[120:123], a[120:123], 0
  v_mul_u32_u24 v254, 48, v0
  s_mul_i32 s93, s58, 61440
  s_sub_u32 s93, s93, 12288
  v_mad_u32_u24 v13, v1, 24, v7
  v_add_u32 v13, 0, v13
  v_and_b32 v14, 8, v13
  v_lshl_or_b32 v14, v7, 1, v14
  v_xor_b32 v14, v14, v9
  v_mul_u32_u24 v17, 0x500, v13
  v_lshl_add_u32 v17, v14, 4, v17
  v_accvgpr_write_b32 a248, v17
  v_mad_u32_u24 v13, v1, 24, v7
  v_add_u32 v13, 4, v13
  v_and_b32 v14, 8, v13
  s_add_u32 m0, s37, 101376
  s_nop 0
  buffer_load_dwordx4 v195, s[8:11], s43 offen offset:0 nt lds
  v_mfma_f32_16x16x32_bf16 a[154:157], a[120:123], a[120:123], 0
  v_lshl_or_b32 v14, v7, 1, v14
  v_xor_b32 v14, v14, v9
  v_mul_u32_u24 v17, 0x500, v13
  v_lshl_add_u32 v17, v14, 4, v17
  v_add_u32 v17, 0xfffffc00, v17
  v_accvgpr_write_b32 a249, v17
  v_mad_u32_u24 v13, v1, 24, v7
  v_add_u32 v13, 8, v13
  v_and_b32 v14, 8, v13
  v_lshl_or_b32 v14, v7, 1, v14
  v_xor_b32 v14, v14, v9
  v_mul_u32_u24 v17, 0x500, v13
  v_lshl_add_u32 v17, v14, 4, v17
  buffer_load_dwordx4 v196, s[8:11], s43 offen offset:1024 nt lds
  buffer_load_dwordx4 v197, s[8:11], s43 offen offset:2048 nt lds
  v_mfma_f32_16x16x32_bf16 a[158:161], a[120:123], a[120:123], 0
  v_add_u32 v17, 0xfffff800, v17
  v_accvgpr_write_b32 a250, v17
  v_mad_u32_u24 v13, v1, 24, v7
  v_add_u32 v13, 12, v13
  v_and_b32 v14, 8, v13
  v_lshl_or_b32 v14, v7, 1, v14
  v_xor_b32 v14, v14, v9
  v_mul_u32_u24 v17, 0x500, v13
  v_lshl_add_u32 v17, v14, 4, v17
  v_accvgpr_write_b32 a251, v17
  v_mad_u32_u24 v13, v1, 24, v7
  v_add_u32 v13, 16, v13
  v_and_b32 v14, 8, v13
  v_lshl_or_b32 v14, v7, 1, v14
  v_mfma_f32_16x16x32_bf16 a[162:165], a[120:123], a[120:123], 0
  v_xor_b32 v14, v14, v9
  v_mul_u32_u24 v17, 0x500, v13
  v_lshl_add_u32 v17, v14, 4, v17
  v_add_u32 v17, 0xfffffc00, v17
  v_accvgpr_write_b32 a252, v17
  v_mad_u32_u24 v13, v1, 24, v7
  v_add_u32 v13, 20, v13
  v_and_b32 v14, 8, v13
  v_lshl_or_b32 v14, v7, 1, v14
  v_xor_b32 v14, v14, v9
  v_mul_u32_u24 v17, 0x500, v13
  v_lshl_add_u32 v17, v14, 4, v17
  v_add_u32 v17, 0xfffff800, v17
  v_accvgpr_write_b32 a253, v17
  v_mfma_f32_16x16x32_bf16 a[166:169], a[120:123], a[120:123], 0
  v_mfma_f32_16x16x32_bf16 a[170:173], a[120:123], a[120:123], 0
  v_mfma_f32_32x32x16_bf16 v[0:15], a[120:123], a[120:123], 0
  v_mfma_f32_32x32x16_bf16 v[16:31], a[120:123], a[120:123], 0
  v_accvgpr_write_b32 a132, 0
  v_accvgpr_write_b32 a133, 0
  v_accvgpr_write_b32 a134, 0
  v_accvgpr_write_b32 a135, 0
  v_accvgpr_write_b32 a140, 0
  v_accvgpr_write_b32 a141, 0
  v_accvgpr_write_b32 a142, 0
  v_accvgpr_write_b32 a143, 0
  v_accvgpr_write_b32 a200, 0
  v_accvgpr_write_b32 a201, 0
  v_accvgpr_write_b32 a202, 0
  v_accvgpr_write_b32 a203, 0
  v_accvgpr_write_b32 a204, 0
  v_accvgpr_write_b32 a205, 0
  v_accvgpr_write_b32 a206, 0
  v_accvgpr_write_b32 a207, 0
  v_accvgpr_write_b32 a208, 0
  v_accvgpr_write_b32 a209, 0
  v_accvgpr_write_b32 a210, 0
  v_accvgpr_write_b32 a211, 0
  v_accvgpr_write_b32 a212, 0
  v_accvgpr_write_b32 a213, 0
  v_accvgpr_write_b32 a214, 0
  v_accvgpr_write_b32 a215, 0
  v_accvgpr_write_b32 a216, 0
  v_accvgpr_write_b32 a217, 0
  v_accvgpr_write_b32 a218, 0
  v_accvgpr_write_b32 a219, 0
  v_accvgpr_write_b32 a220, 0
  v_accvgpr_write_b32 a221, 0
  v_accvgpr_write_b32 a222, 0
  v_accvgpr_write_b32 a223, 0
  v_accvgpr_write_b32 a240, 0
  v_accvgpr_write_b32 a241, 0
  v_accvgpr_write_b32 a242, 0
  v_accvgpr_write_b32 a243, 0
  v_accvgpr_write_b32 a244, 0
  v_accvgpr_write_b32 a245, 0
  v_accvgpr_write_b32 a246, 0
  v_accvgpr_write_b32 a247, 0
  v_mov_b32 v230, 0
  v_mov_b32 v231, 0
  v_mov_b32 v232, 160512
  ds_write_b64 v232, v[230:231]
  v_mov_b32 v206, 141824
  v_mov_b32 v207, 140288
  v_mov_b32 v228, 147968
  v_mov_b32 v229, 146432
LQ:
  ds_read_b64_tr_b16 a[220:221], v206 offset:18688
  ds_read_b64_tr_b16 a[222:223], v207 offset:20224
  v_mfma_f32_32x32x16_bf16 v[96:111], a[200:203], a[132:135], v[96:111]
  ds_read_b64_tr_b16 a[244:245], v228 offset:12544
  ds_read_b64_tr_b16 a[246:247], v229 offset:14080
  s_xor_b32 s40, s40, 73728
  s_add_u32 s39, s40, 24576
  s_waitcnt lgkmcnt(10)
  v_mfma_f32_32x32x16_bf16 v[112:127], a[204:207], a[132:135], v[112:127]
  v_add_u32 v246, s40, v236
  v_add_u32 v247, s40, v237
  v_add_u32 v200, s39, v238
  v_xor_b32 v201, 48, v200
  v_xor_b32 v202, 64, v200
  s_waitcnt lgkmcnt(8)
  v_mfma_f32_16x16x32_bf16 a[166:169], a[240:243], a[140:143], a[166:169]
  v_xor_b32 v203, 112, v200
  v_add_u32 v208, s39, v213
  v_xor_b32 v209, 48, v208
  v_mfma_f32_32x32x16_bf16 v[128:143], a[208:211], a[132:135], v[128:143]
  s_waitcnt vmcnt(18) lgkmcnt(0)
  s_barrier
  ds_read_b128 a[120:123], v246 offset:0
  ds_read_b64_tr_b16 a[176:177], v200 offset:0
  ds_read_b64_tr_b16 a[178:179], v201 offset:1536
  ds_read_b64_tr_b16 a[180:181], v202 offset:0
  ds_read_b64_tr_b16 a[182:183], v203 offset:1536
  v_mfma_f32_32x32x16_bf16 v[144:159], a[212:215], a[132:135], v[144:159]
  ds_read_b64_tr_b16 a[184:185], v200 offset:128
  ds_read_b64_tr_b16 a[186:187], v201 offset:1664
  ds_read_b64_tr_b16 a[188:189], v202 offset:128
  ds_read_b64_tr_b16 a[190:191], v203 offset:1664
  s_xor_b32 s42, s40, 73728
  v_mfma_f32_32x32x16_bf16 v[160:175], a[216:219], a[132:135], v[160:175]
  ds_read_b128 a[136:139], v247 offset:0
  ds_read_b64_tr_b16 a[224:225], v208 offset:0
  ds_read_b64_tr_b16 a[226:227], v209 offset:1536
  s_add_u32 s42, s42, s37
  v_mfma_f32_32x32x16_bf16 v[176:191], a[220:223], a[132:135], v[176:191]
  ds_read_b64_tr_b16 a[192:193], v200 offset:256
  ds_read_b64_tr_b16 a[194:195], v201 offset:1792
  s_add_u32 s44, s44, 786432
  s_waitcnt lgkmcnt(11)
  v_mfma_f32_16x16x32_bf16 a[170:173], a[244:247], a[140:143], a[170:173]
  ds_read_b64_tr_b16 a[196:197], v202 offset:256
  ds_read_b64_tr_b16 a[198:199], v203 offset:1792
  v_mfma_f32_32x32x16_bf16 v[0:15], a[176:179], a[120:123], v[0:15]
  v_xor_b32 v244, 32, v246
  ds_read_b128 a[124:127], v244 offset:0
  ds_read_b64_tr_b16 a[200:201], v200 offset:6144
  ds_read_b64_tr_b16 a[202:203], v201 offset:7680
  s_cmp_eq_u32 s45, 9
  s_cbranch_scc1 XGA9
YGA9:
  s_add_u32 m0, s42, 49152
  s_waitcnt lgkmcnt(12)
  v_mfma_f32_32x32x16_bf16 v[16:31], a[180:183], a[120:123], v[16:31]
  ds_read_b64_tr_b16 a[204:205], v202 offset:6144
  ds_read_b64_tr_b16 a[206:207], v203 offset:7680
  v_mfma_f32_32x32x16_bf16 v[32:47], a[184:187], a[120:123], v[32:47]
  ds_read_b64_tr_b16 a[228:229], v208 offset:128
  ds_read_b64_tr_b16 a[230:231], v209 offset:1664
  buffer_load_dwordx4 v192, s[8:11], s44 offen offset:0 nt lds
  s_waitcnt lgkmcnt(11)
  v_mfma_f32_32x32x16_bf16 v[48:63], a[188:191], a[120:123], v[48:63]
  ds_read_b64_tr_b16 a[208:209], v200 offset:6272
  ds_read_b64_tr_b16 a[210:211], v201 offset:7808
  s_waitcnt lgkmcnt(11)
  v_mfma_f32_16x16x32_bf16 a[150:153], a[224:227], a[136:139], a[150:153]
  ds_read_b64_tr_b16 a[212:213], v202 offset:6272
  ds_read_b64_tr_b16 a[214:215], v203 offset:7808
  v_mfma_f32_32x32x16_bf16 v[64:79], a[192:195], a[120:123], v[64:79]
  ds_read_b64_tr_b16 a[216:217], v200 offset:6400
  ds_read_b64_tr_b16 a[218:219], v201 offset:7936
  buffer_load_dwordx4 v193, s[8:11], s44 offen offset:1024 nt lds
  s_waitcnt lgkmcnt(10)
  v_mfma_f32_32x32x16_bf16 v[80:95], a[196:199], a[120:123], v[80:95]
  ds_read_b64_tr_b16 a[220:221], v202 offset:6400
  ds_read_b64_tr_b16 a[222:223], v203 offset:7936
  v_mfma_f32_32x32x16_bf16 v[0:15], a[200:203], a[124:127], v[0:15]
  ds_read_b64_tr_b16 a[232:233], v208 offset:256
  ds_read_b64_tr_b16 a[234:235], v209 offset:1792
  buffer_load_dwordx4 v194, s[8:11], s44 offen offset:2048 nt lds
  s_waitcnt lgkmcnt(10)
  v_mfma_f32_32x32x16_bf16 v[16:31], a[204:207], a[124:127], v[16:31]
  v_xor_b32 v244, 64, v246
  ds_read_b128 a[128:131], v244 offset:0
  ds_read_b64_tr_b16 a[176:177], v200 offset:12288
  ds_read_b64_tr_b16 a[178:179], v201 offset:13824
  s_waitcnt lgkmcnt(11)
  v_mfma_f32_16x16x32_bf16 a[154:157], a[228:231], a[136:139], a[154:157]
  ds_read_b64_tr_b16 a[180:181], v202 offset:12288
  ds_read_b64_tr_b16 a[182:183], v203 offset:13824
  v_mfma_f32_32x32x16_bf16 v[32:47], a[208:211], a[124:127], v[32:47]
  ds_read_b64_tr_b16 a[184:185], v200 offset:12416
  ds_read_b64_tr_b16 a[186:187], v201 offset:13952
  s_add_u32 m0, s42, 52224
  s_waitcnt lgkmcnt(11)
  v_mfma_f32_32x32x16_bf16 v[48:63], a[212:215], a[124:127], v[48:63]
  ds_read_b64_tr_b16 a[188:189], v202 offset:12416
  ds_read_b64_tr_b16 a[190:191], v203 offset:13952
  buffer_load_dwordx4 v195, s[8:11], s44 offen offset:0 nt lds
  v_mfma_f32_32x32x16_bf16 v[64:79], a[216:219], a[124:127], v[64:79]
  v_xor_b32 v245, 64, v247
  ds_read_b128 a[140:143], v245 offset:0
  ds_read_b64_tr_b16 a[236:237], v208 offset:12288
  ds_read_b64_tr_b16 a[238:239], v209 offset:13824
  s_waitcnt lgkmcnt(12)
  v_mfma_f32_32x32x16_bf16 v[80:95], a[220:223], a[124:127], v[80:95]
  ds_read_b64_tr_b16 a[192:193], v200 offset:12544
  ds_read_b64_tr_b16 a[194:195], v201 offset:14080
  s_waitcnt lgkmcnt(11)
  v_mfma_f32_16x16x32_bf16 a[158:161], a[232:235], a[136:139], a[158:161]
  ds_read_b64_tr_b16 a[196:197], v202 offset:12544
  ds_read_b64_tr_b16 a[198:199], v203 offset:14080
  v_mfma_f32_32x32x16_bf16 v[0:15], a[176:179], a[128:131], v[0:15]
  v_xor_b32 v244, 96, v246
  ds_read_b128 a[132:135], v244 offset:0
  ds_read_b64_tr_b16 a[200:201], v200 offset:18432
  ds_read_b64_tr_b16 a[202:203], v201 offset:19968
  buffer_load_dwordx4 v196, s[8:11], s44 offen offset:1024 nt lds
  s_waitcnt lgkmcnt(12)
  v_mfma_f32_32x32x16_bf16 v[16:31], a[180:183], a[128:131], v[16:31]
  ds_read_b64_tr_b16 a[204:205], v202 offset:18432
  ds_read_b64_tr_b16 a[206:207], v203 offset:19968
  buffer_load_dwordx4 v197, s[8:11], s44 offen offset:2048 nt lds
  v_mfma_f32_32x32x16_bf16 v[32:47], a[184:187], a[128:131], v[32:47]
  ds_read_b64_tr_b16 a[240:241], v208 offset:12416
  ds_read_b64_tr_b16 a[242:243], v209 offset:13952
  s_waitcnt lgkmcnt(11)
  v_mfma_f32_32x32x16_bf16 v[48:63], a[188:191], a[128:131], v[48:63]
  ds_read_b64_tr_b16 a[208:209], v200 offset:18560
  ds_read_b64_tr_b16 a[210:211], v201 offset:20096
  s_waitcnt lgkmcnt(11)
  v_mfma_f32_16x16x32_bf16 a[150:153], a[236:239], a[140:143], a[150:153]
  ds_read_b64_tr_b16 a[212:213], v202 offset:18560
  ds_read_b64_tr_b16 a[214:215], v203 offset:20096
  v_mfma_f32_32x32x16_bf16 v[64:79], a[192:195], a[128:131], v[64:79]
  ds_read_b64_tr_b16 a[216:217], v200 offset:18688
  ds_read_b64_tr_b16 a[218:219], v201 offset:20224
  s_waitcnt lgkmcnt(10)
  v_mfma_f32_32x32x16_bf16 v[80:95], a[196:199], a[128:131], v[80:95]
  ds_read_b64_tr_b16 a[220:221], v202 offset:18688
  ds_read_b64_tr_b16 a[222:223], v203 offset:20224
  s_add_u32 s39, s40, 49152
  v_add_u32 v204, s39, v238
  v_mfma_f32_32x32x16_bf16 v[0:15], a[200:203], a[132:135], v[0:15]
  ds_read_b64_tr_b16 a[244:245], v208 offset:12544
  ds_read_b64_tr_b16 a[246:247], v209 offset:14080
  v_xor_b32 v205, 48, v204
  s_waitcnt lgkmcnt(10)
  v_mfma_f32_32x32x16_bf16 v[16:31], a[204:207], a[132:135], v[16:31]
  v_xor_b32 v206, 64, v204
  v_xor_b32 v207, 112, v204
  v_add_u32 v228, s39, v213
  s_waitcnt lgkmcnt(8)
  v_mfma_f32_16x16x32_bf16 a[154:157], a[240:243], a[140:143], a[154:157]
  v_xor_b32 v229, 48, v228
  v_mfma_f32_32x32x16_bf16 v[32:47], a[208:211], a[132:135], v[32:47]
  s_waitcnt vmcnt(18) lgkmcnt(0)
  s_barrier
  ds_read_b64_tr_b16 a[176:177], v204 offset:0
  ds_read_b64_tr_b16 a[178:179], v205 offset:1536
  ds_read_b64_tr_b16 a[180:181], v206 offset:0
  ds_read_b64_tr_b16 a[182:183], v207 offset:1536
  v_mfma_f32_32x32x16_bf16 v[48:63], a[212:215], a[132:135], v[48:63]
  ds_read_b64_tr_b16 a[184:185], v204 offset:128
  ds_read_b64_tr_b16 a[186:187], v205 offset:1664
  ds_read_b64_tr_b16 a[188:189], v206 offset:128
  ds_read_b64_tr_b16 a[190:191], v207 offset:1664
  s_add_u32 s42, s40, s37
  s_add_u32 s56, s56, 128
  v_mfma_f32_32x32x16_bf16 v[64:79], a[216:219], a[132:135], v[64:79]
  ds_read_b64_tr_b16 a[224:225], v228 offset:0
  ds_read_b64_tr_b16 a[226:227], v229 offset:1536
  s_add_u32 s43, s43, 786432
  v_mfma_f32_32x32x16_bf16 v[80:95], a[220:223], a[132:135], v[80:95]
  ds_read_b64_tr_b16 a[192:193], v204 offset:256
  ds_read_b64_tr_b16 a[194:195], v205 offset:1792
  s_cmp_eq_u32 s45, 8
  s_cbranch_scc1 XGB8
YGB8:
  s_waitcnt lgkmcnt(10)
  v_mfma_f32_16x16x32_bf16 a[158:161], a[244:247], a[140:143], a[158:161]
  ds_read_b64_tr_b16 a[196:197], v206 offset:256
  ds_read_b64_tr_b16 a[198:199], v207 offset:1792
  v_mfma_f32_32x32x16_bf16 v[96:111], a[176:179], a[120:123], v[96:111]
  ds_read_b64_tr_b16 a[200:201], v204 offset:6144
  ds_read_b64_tr_b16 a[202:203], v205 offset:7680
  s_cbranch_vccnz XGB9
YGB9:
  s_add_u32 m0, s42, 0
  s_waitcnt lgkmcnt(10)
  v_mfma_f32_32x32x16_bf16 v[112:127], a[180:183], a[120:123], v[112:127]
  ds_read_b64_tr_b16 a[204:205], v206 offset:6144
  ds_read_b64_tr_b16 a[206:207], v207 offset:7680
  buffer_load_dwordx4 v198, s[4:7], s56 offen offset:0 nt lds
  s_cbranch_vccnz XGC0
YGC0:
  v_mfma_f32_32x32x16_bf16 v[128:143], a[184:187], a[120:123], v[128:143]
  ds_read_b64_tr_b16 a[228:229], v228 offset:128
  ds_read_b64_tr_b16 a[230:231], v229 offset:1664
  buffer_load_dwordx4 v199, s[4:7], s56 offen offset:1024 nt lds
  s_waitcnt lgkmcnt(10)
  v_mfma_f32_32x32x16_bf16 v[144:159], a[188:191], a[120:123], v[144:159]
  ds_read_b64_tr_b16 a[208:209], v204 offset:6272
  ds_read_b64_tr_b16 a[210:211], v205 offset:7808
  buffer_load_dwordx4 v240, s[4:7], s56 offen offset:2048 nt lds
  s_cbranch_vccnz XGC1
YGC1:
  s_waitcnt lgkmcnt(10)
  v_mfma_f32_16x16x32_bf16 a[162:165], a[224:227], a[136:139], a[162:165]
  ds_read_b64_tr_b16 a[212:213], v206 offset:6272
  ds_read_b64_tr_b16 a[214:215], v207 offset:7808
  v_mfma_f32_32x32x16_bf16 v[160:175], a[192:195], a[120:123], v[160:175]
  ds_read_b64_tr_b16 a[216:217], v204 offset:6400
  ds_read_b64_tr_b16 a[218:219], v205 offset:7936
  s_add_u32 m0, s42, 3072
  s_cbranch_vccnz XGC2
YGC2:
  s_waitcnt lgkmcnt(10)
  v_mfma_f32_32x32x16_bf16 v[176:191], a[196:199], a[120:123], v[176:191]
  ds_read_b64_tr_b16 a[220:221], v206 offset:6400
  ds_read_b64_tr_b16 a[222:223], v207 offset:7936
  buffer_load_dwordx4 v241, s[4:7], s56 offen offset:0 nt lds
  v_mfma_f32_32x32x16_bf16 v[96:111], a[200:203], a[124:127], v[96:111]
  ds_read_b64_tr_b16 a[232:233], v228 offset:256
  ds_read_b64_tr_b16 a[234:235], v229 offset:1792
  buffer_load_dwordx4 v242, s[4:7], s56 offen offset:1024 nt lds
  s_waitcnt lgkmcnt(10)
  v_mfma_f32_32x32x16_bf16 v[112:127], a[204:207], a[124:127], v[112:127]
  ds_read_b64_tr_b16 a[176:177], v204 offset:12288
  ds_read_b64_tr_b16 a[178:179], v205 offset:13824
  s_cbranch_vccnz XGC3
YGC3:
  s_waitcnt lgkmcnt(10)
  v_mfma_f32_16x16x32_bf16 a[166:169], a[228:231], a[136:139], a[166:169]
  ds_read_b64_tr_b16 a[180:181], v206 offset:12288
  ds_read_b64_tr_b16 a[182:183], v207 offset:13824
  v_mfma_f32_32x32x16_bf16 v[128:143], a[208:211], a[124:127], v[128:143]
  ds_read_b64_tr_b16 a[184:185], v204 offset:12416
  ds_read_b64_tr_b16 a[186:187], v205 offset:13952
  buffer_load_dwordx4 v243, s[4:7], s56 offen offset:2048 nt lds
  s_add_u32 m0, s42, 24576
  s_cbranch_vccnz XGC4
YGC4:
  s_waitcnt lgkmcnt(10)
  v_mfma_f32_32x32x16_bf16 v[144:159], a[212:215], a[124:127], v[144:159]
  ds_read_b64_tr_b16 a[188:189], v206 offset:12416
  ds_read_b64_tr_b16 a[190:191], v207 offset:13952
  buffer_load_dwordx4 v192, s[8:11], s43 offen offset:0 nt lds
  v_mfma_f32_32x32x16_bf16 v[160:175], a[216:219], a[124:127], v[160:175]
  ds_read_b64_tr_b16 a[236:237], v228 offset:12288
  ds_read_b64_tr_b16 a[238:239], v229 offset:13824
  s_cbranch_vccnz XGC5
YGC5:
  s_waitcnt lgkmcnt(10)
  v_mfma_f32_32x32x16_bf16 v[176:191], a[220:223], a[124:127], v[176:191]
  ds_read_b64_tr_b16 a[192:193], v204 offset:12544
  ds_read_b64_tr_b16 a[194:195], v205 offset:14080
  buffer_load_dwordx4 v193, s[8:11], s43 offen offset:1024 nt lds
  s_waitcnt lgkmcnt(10)
  v_mfma_f32_16x16x32_bf16 a[170:173], a[232:235], a[136:139], a[170:173]
  ds_read_b64_tr_b16 a[196:197], v206 offset:12544
  ds_read_b64_tr_b16 a[198:199], v207 offset:14080
  v_mfma_f32_32x32x16_bf16 v[96:111], a[176:179], a[128:131], v[96:111]
  ds_read_b64_tr_b16 a[200:201], v204 offset:18432
  ds_read_b64_tr_b16 a[202:203], v205 offset:19968
  buffer_load_dwordx4 v194, s[8:11], s43 offen offset:2048 nt lds
  s_add_u32 m0, s42, 27648
  s_cbranch_vccnz XGC6
YGC6:
  s_waitcnt lgkmcnt(10)
  v_mfma_f32_32x32x16_bf16 v[112:127], a[180:183], a[128:131], v[112:127]
  ds_read_b64_tr_b16 a[204:205], v206 offset:18432
  ds_read_b64_tr_b16 a[206:207], v207 offset:19968
  v_mfma_f32_32x32x16_bf16 v[128:143], a[184:187], a[128:131], v[128:143]
  ds_read_b64_tr_b16 a[240:241], v228 offset:12416
  ds_read_b64_tr_b16 a[242:243], v229 offset:13952
  buffer_load_dwordx4 v195, s[8:11], s43 offen offset:0 nt lds
  s_cbranch_vccnz XGC7
YGC7:
  s_waitcnt lgkmcnt(10)
  v_mfma_f32_32x32x16_bf16 v[144:159], a[188:191], a[128:131], v[144:159]
  ds_read_b64_tr_b16 a[208:209], v204 offset:18560
  ds_read_b64_tr_b16 a[210:211], v205 offset:20096
  buffer_load_dwordx4 v196, s[8:11], s43 offen offset:1024 nt lds
  s_waitcnt lgkmcnt(10)
  v_mfma_f32_16x16x32_bf16 a[162:165], a[236:239], a[140:143], a[162:165]
  ds_read_b64_tr_b16 a[212:213], v206 offset:18560
  ds_read_b64_tr_b16 a[214:215], v207 offset:20096
  v_mfma_f32_32x32x16_bf16 v[160:175], a[192:195], a[128:131], v[160:175]
  ds_read_b64_tr_b16 a[216:217], v204 offset:18688
  ds_read_b64_tr_b16 a[218:219], v205 offset:20224
  buffer_load_dwordx4 v197, s[8:11], s43 offen offset:2048 nt lds
  s_cbranch_vccnz XGC8
YGC8:
  s_waitcnt lgkmcnt(10)
  v_mfma_f32_32x32x16_bf16 v[176:191], a[196:199], a[128:131], v[176:191]
  s_add_u32 s45, s45, 1
  s_cmp_lg_u32 s45, 10
  s_cbranch_scc1 LQ
  ds_read_b64_tr_b16 a[220:221], v206 offset:18688
  ds_read_b64_tr_b16 a[222:223], v207 offset:20224
  v_mfma_f32_32x32x16_bf16 v[96:111], a[200:203], a[132:135], v[96:111]
  ds_read_b64_tr_b16 a[244:245], v228 offset:12544
  ds_read_b64_tr_b16 a[246:247], v229 offset:14080
  s_waitcnt lgkmcnt(10)
  v_mfma_f32_32x32x16_bf16 v[112:127], a[204:207], a[132:135], v[112:127]
  s_waitcnt lgkmcnt(8)
  v_mfma_f32_16x16x32_bf16 a[166:169], a[240:243], a[140:143], a[166:169]
  v_mfma_f32_32x32x16_bf16 v[128:143], a[208:211], a[132:135], v[128:143]
  s_add_u32 s42, s39, s37
  s_add_u32 s39, s39, 24576
  s_cmp_eq_u32 s39, 147456
  s_cselect_b32 s39, 0, s39
  v_add_u32 v200, s39, v210
  v_xor_b32 v201, 32, v200
  v_xor_b32 v202, 64, v200
  v_xor_b32 v203, 96, v200
  v_add_u32 v208, s39, v211
  v_xor_b32 v209, 64, v208
  v_xor_b32 v244, 64, v227
  s_waitcnt vmcnt(24) lgkmcnt(0)
  s_barrier
  ds_read_b128 a[176:179], v200 offset:0
  ds_read_b128 a[180:183], v201 offset:0
  v_mfma_f32_32x32x16_bf16 v[144:159], a[212:215], a[132:135], v[144:159]
  ds_read_b128 a[184:187], v202 offset:0
  ds_read_b128 a[96:99], v227 offset:0
  ds_read_b128 a[224:227], v208 offset:0
  s_mov_b32 s43, 73728
  v_mfma_f32_32x32x16_bf16 v[160:175], a[216:219], a[132:135], v[160:175]
  ds_read_b128 a[188:191], v203 offset:0
  v_mfma_f32_32x32x16_bf16 v[176:191], a[220:223], a[132:135], v[176:191]
  ds_read_b128 a[192:195], v200 offset:128
  s_add_u32 m0, s42, 0
  s_waitcnt lgkmcnt(6)
  v_mfma_f32_16x16x32_bf16 a[170:173], a[244:247], a[140:143], a[170:173]
  ds_read_b128 a[100:103], v244 offset:0
  ds_read_b128 a[228:231], v209 offset:0
  v_mfma_f32_32x32x16_bf16 v[0:15], a[176:179], a[0:3], 0
  ds_read_b128 a[196:199], v201 offset:128
  s_waitcnt lgkmcnt(7)
  v_mfma_f32_32x32x16_bf16 v[0:15], a[180:183], a[4:7], v[0:15]
  ds_read_b128 a[200:203], v202 offset:128
  buffer_load_dwordx4 v192, s[12:15], s43 offen offset:0 nt lds
  v_cvt_pk_bf16_f32 v246, v96, v97
  v_accvgpr_write_b32 a48, v246
  v_cvt_pk_bf16_f32 v247, v98, v99
  v_accvgpr_write_b32 a49, v247
  v_mfma_f32_32x32x16_bf16 v[0:15], a[184:187], a[8:11], v[0:15]
  ds_read_b128 a[104:107], v227 offset:128
  ds_read_b128 a[232:235], v208 offset:128
  v_cvt_pk_bf16_f32 v246, v100, v101
  v_accvgpr_write_b32 a50, v246
  v_cvt_pk_bf16_f32 v247, v102, v103
  v_accvgpr_write_b32 a51, v247
  s_waitcnt lgkmcnt(7)
  v_mfma_f32_16x16x32_bf16 v[240:243], a[224:227], a[96:99], 0
  ds_read_b128 a[204:207], v203 offset:128
  buffer_load_dwordx4 v193, s[12:15], s43 offen offset:1024 nt lds
  v_cvt_pk_bf16_f32 v246, v104, v105
  v_accvgpr_write_b32 a52, v246
  v_cvt_pk_bf16_f32 v247, v106, v107
  v_accvgpr_write_b32 a53, v247
  v_accvgpr_read_b32 v250, a162
  v_accvgpr_read_b32 v251, a163
  v_mfma_f32_32x32x16_bf16 v[0:15], a[188:191], a[12:15], v[0:15]
  ds_read_b128 a[208:211], v200 offset:256
  v_cvt_pk_bf16_f32 v246, v108, v109
  v_accvgpr_write_b32 a54, v246
  v_cvt_pk_bf16_f32 v247, v110, v111
  v_accvgpr_write_b32 a55, v247
  v_accvgpr_read_b32 v252, a164
  s_waitcnt lgkmcnt(6)
  v_mfma_f32_32x32x16_bf16 v[0:15], a[192:195], a[16:19], v[0:15]
  ds_read_b128 a[108:111], v244 offset:128
  ds_read_b128 a[236:239], v209 offset:128
  v_cvt_pk_bf16_f32 v246, v112, v113
  v_accvgpr_write_b32 a56, v246
  v_cvt_pk_bf16_f32 v247, v114, v115
  v_accvgpr_write_b32 a57, v247
  v_accvgpr_read_b32 v253, a165
  v_mfma_f32_16x16x32_bf16 v[240:243], a[228:231], a[100:103], v[240:243]
  ds_read_b128 a[212:215], v201 offset:256
  buffer_load_dwordx4 v194, s[12:15], s43 offen offset:2048 nt lds
  v_cvt_pk_bf16_f32 v246, v116, v117
  v_accvgpr_write_b32 a58, v246
  v_cvt_pk_bf16_f32 v247, v118, v119
  v_accvgpr_write_b32 a59, v247
  v_cvt_pk_bf16_f32 v250, v250, v251
  v_cvt_pk_bf16_f32 v251, v252, v253
  s_waitcnt lgkmcnt(7)
  v_mfma_f32_32x32x16_bf16 v[0:15], a[196:199], a[20:23], v[0:15]
  ds_read_b128 a[216:219], v202 offset:256
  v_cvt_pk_bf16_f32 v246, v120, v121
  v_accvgpr_write_b32 a60, v246
  v_cvt_pk_bf16_f32 v247, v122, v123
  v_accvgpr_write_b32 a61, v247
  ds_write_b64 v226, v[250:251] offset:6144
  v_mfma_f32_32x32x16_bf16 v[0:15], a[200:203], a[24:27], v[0:15]
  ds_read_b128 a[112:115], v227 offset:256
  ds_read_b128 a[240:243], v208 offset:256
  s_add_u32 m0, s42, 3072
  v_cvt_pk_bf16_f32 v246, v124, v125
  v_accvgpr_write_b32 a62, v246
  v_cvt_pk_bf16_f32 v247, v126, v127
  v_accvgpr_write_b32 a63, v247
  v_accvgpr_read_b32 v250, a166
  s_waitcnt lgkmcnt(8)
  v_mfma_f32_16x16x32_bf16 v[240:243], a[232:235], a[104:107], v[240:243]
  ds_read_b128 a[220:223], v203 offset:256
  v_cvt_pk_bf16_f32 v246, v128, v129
  v_accvgpr_write_b32 a64, v246
  v_cvt_pk_bf16_f32 v247, v130, v131
  v_accvgpr_write_b32 a65, v247
  v_accvgpr_read_b32 v251, a167
  v_accvgpr_read_b32 v252, a168
  v_mfma_f32_32x32x16_bf16 v[0:15], a[204:207], a[28:31], v[0:15]
  ds_read_b128 a[176:179], v200 offset:12288
  v_cvt_pk_bf16_f32 v246, v132, v133
  v_accvgpr_write_b32 a66, v246
  v_cvt_pk_bf16_f32 v247, v134, v135
  v_accvgpr_write_b32 a67, v247
  v_accvgpr_read_b32 v253, a169
  s_waitcnt lgkmcnt(7)
  v_mfma_f32_32x32x16_bf16 v[0:15], a[208:211], a[32:35], v[0:15]
  ds_read_b128 a[116:119], v244 offset:256
  ds_read_b128 a[244:247], v209 offset:256
  buffer_load_dwordx4 v195, s[12:15], s43 offen offset:0 nt lds
  v_cvt_pk_bf16_f32 v246, v136, v137
  v_accvgpr_write_b32 a68, v246
  v_cvt_pk_bf16_f32 v247, v138, v139
  v_accvgpr_write_b32 a69, v247
  v_cvt_pk_bf16_f32 v250, v250, v251
  v_mfma_f32_16x16x32_bf16 v[240:243], a[236:239], a[108:111], v[240:243]
  ds_read_b128 a[180:183], v201 offset:12288
  v_cvt_pk_bf16_f32 v246, v140, v141
  v_accvgpr_write_b32 a70, v246
  v_cvt_pk_bf16_f32 v247, v142, v143
  v_accvgpr_write_b32 a71, v247
  v_cvt_pk_bf16_f32 v251, v252, v253
  ds_write_b64 v226, v[250:251] offset:6272
  s_waitcnt lgkmcnt(9)
  v_mfma_f32_32x32x16_bf16 v[0:15], a[212:215], a[36:39], v[0:15]
  ds_read_b128 a[184:187], v202 offset:12288
  buffer_load_dwordx4 v196, s[12:15], s43 offen offset:1024 nt lds
  v_cvt_pk_bf16_f32 v246, v144, v145
  v_accvgpr_write_b32 a72, v246
  v_cvt_pk_bf16_f32 v247, v146, v147
  v_accvgpr_write_b32 a73, v247
  v_accvgpr_read_b32 v250, a170
  v_mfma_f32_32x32x16_bf16 v[0:15], a[216:219], a[40:43], v[0:15]
  ds_read_b128 a[188:191], v203 offset:12288
  v_cvt_pk_bf16_f32 v246, v148, v149
  v_accvgpr_write_b32 a74, v246
  v_cvt_pk_bf16_f32 v247, v150, v151
  v_accvgpr_write_b32 a75, v247
  v_accvgpr_read_b32 v251, a171
  s_waitcnt lgkmcnt(7)
  v_mfma_f32_16x16x32_bf16 v[240:243], a[240:243], a[112:115], v[240:243]
  ds_read_b128 a[192:195], v200 offset:12416
  v_cvt_pk_bf16_f32 v246, v152, v153
  v_accvgpr_write_b32 a76, v246
  v_cvt_pk_bf16_f32 v247, v154, v155
  v_accvgpr_write_b32 a77, v247
  v_accvgpr_read_b32 v252, a172
  v_accvgpr_read_b32 v253, a173
  v_mfma_f32_32x32x16_bf16 v[0:15], a[220:223], a[44:47], v[0:15]
  ds_read_b128 a[196:199], v201 offset:12416
  buffer_load_dwordx4 v197, s[12:15], s43 offen offset:2048 nt lds
  v_cvt_pk_bf16_f32 v246, v156, v157
  v_accvgpr_write_b32 a78, v246
  v_cvt_pk_bf16_f32 v247, v158, v159
  v_accvgpr_write_b32 a79, v247
  v_cvt_pk_bf16_f32 v250, v250, v251
  s_waitcnt lgkmcnt(6)
  v_mfma_f32_32x32x16_bf16 v[16:31], a[176:179], a[0:3], 0
  ds_read_b128 a[200:203], v202 offset:12416
  v_cvt_pk_bf16_f32 v246, v160, v161
  v_accvgpr_write_b32 a80, v246
  v_cvt_pk_bf16_f32 v247, v162, v163
  v_accvgpr_write_b32 a81, v247
  v_cvt_pk_bf16_f32 v251, v252, v253
  v_mfma_f32_16x16x32_bf16 v[240:243], a[244:247], a[116:119], v[240:243]
  ds_read_b128 a[204:207], v203 offset:12416
  v_cvt_pk_bf16_f32 v246, v164, v165
  v_accvgpr_write_b32 a82, v246
  v_cvt_pk_bf16_f32 v247, v166, v167
  v_accvgpr_write_b32 a83, v247
  ds_write_b64 v226, v[250:251] offset:6400
  s_waitcnt lgkmcnt(6)
  v_mfma_f32_32x32x16_bf16 v[16:31], a[180:183], a[4:7], v[16:31]
  ds_read_b128 a[208:211], v200 offset:12544
  v_cvt_pk_bf16_f32 v246, v168, v169
  v_accvgpr_write_b32 a84, v246
  v_cvt_pk_bf16_f32 v247, v170, v171
  v_accvgpr_write_b32 a85, v247
  v_mfma_f32_32x32x16_bf16 v[16:31], a[184:187], a[8:11], v[16:31]
  ds_read_b128 a[212:215], v201 offset:12544
  v_max3_f32 v230, v240, v241, v242
  v_max_f32 v230, v230, v243
  v_cvt_pk_bf16_f32 v246, v172, v173
  v_accvgpr_write_b32 a86, v246
  v_cvt_pk_bf16_f32 v247, v174, v175
  v_accvgpr_write_b32 a87, v247
  s_waitcnt lgkmcnt(6)
  v_mfma_f32_32x32x16_bf16 v[16:31], a[188:191], a[12:15], v[16:31]
  ds_read_b128 a[216:219], v202 offset:12544
  v_mov_b32 v231, v230
  s_nop 1
  v_permlane16_swap_b32 v231, v230
  v_cvt_pk_bf16_f32 v246, v176, v177
  v_accvgpr_write_b32 a88, v246
  v_cvt_pk_bf16_f32 v247, v178, v179
  v_accvgpr_write_b32 a89, v247
  v_mfma_f32_32x32x16_bf16 v[16:31], a[192:195], a[16:19], v[16:31]
  ds_read_b128 a[220:223], v203 offset:12544
  v_max_f32 v230, v230, v231
  v_mov_b32 v231, v230
  v_cvt_pk_bf16_f32 v246, v180, v181
  v_accvgpr_write_b32 a90, v246
  v_cvt_pk_bf16_f32 v247, v182, v183
  v_accvgpr_write_b32 a91, v247
  s_waitcnt lgkmcnt(6)
  v_mfma_f32_32x32x16_bf16 v[16:31], a[196:199], a[20:23], v[16:31]
  v_permlane32_swap_b32 v231, v230
  v_max_f32 v230, v230, v231
  v_cvt_pk_bf16_f32 v246, v184, v185
  v_accvgpr_write_b32 a92, v246
  v_cvt_pk_bf16_f32 v247, v186, v187
  v_accvgpr_write_b32 a93, v247
  v_mfma_f32_32x32x16_bf16 v[16:31], a[200:203], a[24:27], v[16:31]
  ds_write_b32 v224, v230 offset:0
  v_cvt_pk_bf16_f32 v246, v188, v189
  v_accvgpr_write_b32 a94, v246
  v_cvt_pk_bf16_f32 v247, v190, v191
  v_accvgpr_write_b32 a95, v247
  s_waitcnt lgkmcnt(4)
  v_mfma_f32_32x32x16_bf16 v[16:31], a[204:207], a[28:31], v[16:31]
  s_add_u32 s42, s39, s37
  s_add_u32 s39, s39, 24576
  s_cmp_eq_u32 s39, 147456
  s_cselect_b32 s39, 0, s39
  v_add_u32 v200, s39, v210
  v_xor_b32 v201, 32, v200
  v_xor_b32 v202, 64, v200
  v_xor_b32 v203, 96, v200
  v_add_u32 v208, s39, v211
  v_xor_b32 v209, 64, v208
  s_waitcnt vmcnt(24) lgkmcnt(0)
  s_barrier
  ds_read_b128 a[176:179], v200 offset:0
  ds_read_b128 a[180:183], v201 offset:0
  v_max3_f32 v218, v0, v1, v2
  v_max3_f32 v218, v218, v3, v4
  v_mfma_f32_32x32x16_bf16 v[16:31], a[208:211], a[32:35], v[16:31]
  ds_read_b128 a[184:187], v202 offset:0
  ds_read_b128 a[224:227], v208 offset:0
  v_max3_f32 v218, v218, v5, v6
  v_max3_f32 v218, v218, v7, v8
  s_mov_b32 s43, 49152
  ds_read_b128 v[232:235], v225 offset:0
  v_mfma_f32_32x32x16_bf16 v[16:31], a[212:215], a[36:39], v[16:31]
  ds_read_b128 a[188:191], v203 offset:0
  v_max3_f32 v218, v218, v9, v10
  v_max3_f32 v218, v218, v11, v12
  v_mfma_f32_32x32x16_bf16 v[16:31], a[216:219], a[40:43], v[16:31]
  ds_read_b128 a[192:195], v200 offset:128
  v_max3_f32 v218, v218, v13, v14
  v_max_f32 v218, v218, v15
  s_add_u32 m0, s42, 0
  v_mfma_f32_32x32x16_bf16 v[16:31], a[220:223], a[44:47], v[16:31]
  ds_read_b128 a[228:231], v209 offset:0
  s_waitcnt lgkmcnt(6)
  v_mfma_f32_32x32x16_bf16 v[96:111], a[176:179], a[0:3], 0
  ds_read_b128 a[196:199], v201 offset:128
  v_mfma_f32_32x32x16_bf16 v[96:111], a[180:183], a[4:7], v[96:111]
  ds_read_b128 a[200:203], v202 offset:128
  buffer_load_dwordx4 v192, s[16:19], s43 offen offset:0 nt lds
  s_nop 4
  v_max3_f32 v218, v218, v16, v17
  v_max3_f32 v218, v218, v18, v19
  v_max3_f32 v218, v218, v20, v21
  v_max3_f32 v218, v218, v22, v23
  v_max3_f32 v218, v218, v24, v25
  v_max3_f32 v218, v218, v26, v27
  s_waitcnt lgkmcnt(6)
  v_mfma_f32_32x32x16_bf16 v[96:111], a[184:187], a[8:11], v[96:111]
  ds_read_b128 a[232:235], v208 offset:128
  v_max3_f32 v218, v218, v28, v29
  v_max3_f32 v218, v218, v30, v31
  v_mov_b32 v228, v218
  s_nop 1
  v_permlane32_swap_b32 v228, v218
  v_max_f32 v218, v218, v228
  s_waitcnt lgkmcnt(6)
  v_max3_f32 v232, v232, v233, v234
  v_mfma_f32_16x16x32_bf16 v[188:191], a[224:227], a[96:99], 0
  ds_read_b128 a[204:207], v203 offset:128
  buffer_load_dwordx4 v193, s[16:19], s43 offen offset:1024 nt lds
  v_mov_b32 v214, v218
  v_mul_f32 v215, s47, v214
  v_mov_b32 v216, 0
  v_fma_f32 v0, v0, s47, -v215
  v_exp_f32 v0, v0
  v_max_f32 v232, v232, v235
  v_mul_f32 v219, s47, v232
  s_waitcnt lgkmcnt(5)
  v_mfma_f32_32x32x16_bf16 v[96:111], a[188:191], a[12:15], v[96:111]
  ds_read_b128 a[208:211], v200 offset:256
  v_fma_f32 v1, v1, s47, -v215
  v_exp_f32 v1, v1
  v_add_f32 v216, v216, v0
  v_fma_f32 v2, v2, s47, -v215
  v_exp_f32 v2, v2
  v_mov_b32 v220, 0
  v_mfma_f32_32x32x16_bf16 v[96:111], a[192:195], a[16:19], v[96:111]
  ds_read_b128 a[236:239], v209 offset:128
  v_add_f32 v216, v216, v1
  v_fma_f32 v3, v3, s47, -v215
  v_exp_f32 v3, v3
  v_add_f32 v216, v216, v2
  v_fma_f32 v4, v4, s47, -v215
  v_fma_f32 v240, v240, s47, -v219
  v_exp_f32 v240, v240
  s_waitcnt lgkmcnt(5)
  v_mfma_f32_16x16x32_bf16 v[188:191], a[228:231], a[100:103], v[188:191]
  ds_read_b128 a[212:215], v201 offset:256
  buffer_load_dwordx4 v194, s[16:19], s43 offen offset:2048 nt lds
  v_exp_f32 v4, v4
  v_add_f32 v216, v216, v3
  v_fma_f32 v5, v5, s47, -v215
  v_exp_f32 v5, v5
  v_add_f32 v216, v216, v4
  v_fma_f32 v241, v241, s47, -v219
  v_exp_f32 v241, v241
  v_mfma_f32_32x32x16_bf16 v[96:111], a[196:199], a[20:23], v[96:111]
  ds_read_b128 a[216:219], v202 offset:256
  v_fma_f32 v6, v6, s47, -v215
  v_exp_f32 v6, v6
  v_add_f32 v216, v216, v5
  v_fma_f32 v7, v7, s47, -v215
  v_exp_f32 v7, v7
  v_add_f32 v220, v220, v240
  s_waitcnt lgkmcnt(5)
  v_mfma_f32_32x32x16_bf16 v[96:111], a[200:203], a[24:27], v[96:111]
  ds_read_b128 a[240:243], v208 offset:256
  s_add_u32 m0, s42, 3072
  v_add_f32 v216, v216, v6
  v_fma_f32 v8, v8, s47, -v215
  v_exp_f32 v8, v8
  v_add_f32 v216, v216, v7
  v_fma_f32 v9, v9, s47, -v215
  v_fma_f32 v242, v242, s47, -v219
  v_exp_f32 v242, v242
  v_mfma_f32_16x16x32_bf16 v[188:191], a[232:235], a[104:107], v[188:191]
  ds_read_b128 a[220:223], v203 offset:256
  v_exp_f32 v9, v9
  v_add_f32 v216, v216, v8
  v_fma_f32 v10, v10, s47, -v215
  v_exp_f32 v10, v10
  v_add_f32 v216, v216, v9
  v_add_f32 v220, v220, v241
  s_waitcnt lgkmcnt(5)
  v_mfma_f32_32x32x16_bf16 v[96:111], a[204:207], a[28:31], v[96:111]
  ds_read_b128 a[176:179], v200 offset:12288
  v_fma_f32 v11, v11, s47, -v215
  v_exp_f32 v11, v11
  v_add_f32 v216, v216, v10
  v_fma_f32 v12, v12, s47, -v215
  v_exp_f32 v12, v12
  v_fma_f32 v243, v243, s47, -v219
  v_exp_f32 v243, v243
  v_mfma_f32_32x32x16_bf16 v[96:111], a[208:211], a[32:35], v[96:111]
  ds_read_b128 a[244:247], v209 offset:256
  buffer_load_dwordx4 v195, s[16:19], s43 offen offset:0 nt lds
  v_add_f32 v216, v216, v11
  v_fma_f32 v13, v13, s47, -v215
  v_exp_f32 v13, v13
  v_add_f32 v216, v216, v12
  v_fma_f32 v14, v14, s47, -v215
  v_add_f32 v220, v220, v242
  v_add_f32 v220, v220, v243
  s_waitcnt lgkmcnt(5)
  v_mfma_f32_16x16x32_bf16 v[188:191], a[236:239], a[108:111], v[188:191]
  ds_read_b128 a[180:183], v201 offset:12288
  v_exp_f32 v14, v14
  v_add_f32 v216, v216, v13
  v_fma_f32 v15, v15, s47, -v215
  v_exp_f32 v15, v15
  v_add_f32 v216, v216, v14
  v_cvt_pk_bf16_f32 v232, v240, v241
  v_mfma_f32_32x32x16_bf16 v[96:111], a[212:215], a[36:39], v[96:111]
  ds_read_b128 a[184:187], v202 offset:12288
  buffer_load_dwordx4 v196, s[16:19], s43 offen offset:1024 nt lds
  v_fma_f32 v16, v16, s47, -v215
  v_exp_f32 v16, v16
  v_add_f32 v216, v216, v15
  v_fma_f32 v17, v17, s47, -v215
  v_exp_f32 v17, v17
  v_cvt_pk_bf16_f32 v233, v242, v243
  ds_write_b64 v222, v[232:233] offset:0
  s_waitcnt lgkmcnt(6)
  v_mfma_f32_32x32x16_bf16 v[96:111], a[216:219], a[40:43], v[96:111]
  ds_read_b128 a[188:191], v203 offset:12288
  v_add_f32 v216, v216, v16
  v_fma_f32 v18, v18, s47, -v215
  v_exp_f32 v18, v18
  v_add_f32 v216, v216, v17
  v_fma_f32 v19, v19, s47, -v215
  v_xor_b32 v222, 0x800, v222
  v_mfma_f32_16x16x32_bf16 v[188:191], a[240:243], a[112:115], v[188:191]
  ds_read_b128 a[192:195], v200 offset:12416
  v_exp_f32 v19, v19
  v_add_f32 v216, v216, v18
  v_fma_f32 v20, v20, s47, -v215
  v_exp_f32 v20, v20
  v_add_f32 v216, v216, v19
  s_waitcnt lgkmcnt(6)
  v_mfma_f32_32x32x16_bf16 v[96:111], a[220:223], a[44:47], v[96:111]
  ds_read_b128 a[196:199], v201 offset:12416
  buffer_load_dwordx4 v197, s[16:19], s43 offen offset:2048 nt lds
  v_fma_f32 v21, v21, s47, -v215
  v_exp_f32 v21, v21
  v_add_f32 v216, v216, v20
  v_fma_f32 v22, v22, s47, -v215
  v_exp_f32 v22, v22
  v_mfma_f32_32x32x16_bf16 v[112:127], a[176:179], a[0:3], 0
  ds_read_b128 a[200:203], v202 offset:12416
  v_add_f32 v216, v216, v21
  v_fma_f32 v23, v23, s47, -v215
  v_exp_f32 v23, v23
  v_add_f32 v216, v216, v22
  v_fma_f32 v24, v24, s47, -v215
  s_waitcnt lgkmcnt(6)
  v_mfma_f32_16x16x32_bf16 v[188:191], a[244:247], a[116:119], v[188:191]
  ds_read_b128 a[204:207], v203 offset:12416
  v_exp_f32 v24, v24
  v_add_f32 v216, v216, v23
  v_fma_f32 v25, v25, s47, -v215
  v_exp_f32 v25, v25
  v_add_f32 v216, v216, v24
  v_mfma_f32_32x32x16_bf16 v[112:127], a[180:183], a[4:7], v[112:127]
  ds_read_b128 a[208:211], v200 offset:12544
  v_fma_f32 v26, v26, s47, -v215
  v_exp_f32 v26, v26
  v_add_f32 v216, v216, v25
  v_fma_f32 v27, v27, s47, -v215
  v_exp_f32 v27, v27
  s_waitcnt lgkmcnt(5)
  v_mfma_f32_32x32x16_bf16 v[112:127], a[184:187], a[8:11], v[112:127]
  ds_read_b128 a[212:215], v201 offset:12544
  v_max3_f32 v230, v188, v189, v190
  v_max_f32 v230, v230, v191
  v_add_f32 v216, v216, v26
  v_fma_f32 v28, v28, s47, -v215
  v_exp_f32 v28, v28
  v_add_f32 v216, v216, v27
  v_fma_f32 v29, v29, s47, -v215
  v_mfma_f32_32x32x16_bf16 v[112:127], a[188:191], a[12:15], v[112:127]
  ds_read_b128 a[216:219], v202 offset:12544
  v_mov_b32 v231, v230
  s_nop 1
  v_permlane16_swap_b32 v231, v230
  v_exp_f32 v29, v29
  v_add_f32 v216, v216, v28
  v_fma_f32 v30, v30, s47, -v215
  v_exp_f32 v30, v30
  v_add_f32 v216, v216, v29
  s_waitcnt lgkmcnt(5)
  v_mfma_f32_32x32x16_bf16 v[112:127], a[192:195], a[16:19], v[112:127]
  ds_read_b128 a[220:223], v203 offset:12544
  v_max_f32 v230, v230, v231
  v_mov_b32 v231, v230
  v_fma_f32 v31, v31, s47, -v215
  v_exp_f32 v31, v31
  v_add_f32 v216, v216, v30
  v_add_f32 v216, v216, v31
  v_cvt_pk_bf16_f32 v160, v0, v1
  v_mfma_f32_32x32x16_bf16 v[112:127], a[196:199], a[20:23], v[112:127]
  v_permlane32_swap_b32 v231, v230
  v_max_f32 v230, v230, v231
  v_cvt_pk_bf16_f32 v161, v2, v3
  v_cvt_pk_bf16_f32 v162, v4, v5
  v_cvt_pk_bf16_f32 v163, v6, v7
  v_cvt_pk_bf16_f32 v164, v8, v9
  v_cvt_pk_bf16_f32 v165, v10, v11
  s_waitcnt lgkmcnt(4)
  v_mfma_f32_32x32x16_bf16 v[112:127], a[200:203], a[24:27], v[112:127]
  ds_write_b32 v224, v230 offset:256
  v_cvt_pk_bf16_f32 v166, v12, v13
  v_cvt_pk_bf16_f32 v167, v14, v15
  v_cvt_pk_bf16_f32 v168, v16, v17
  v_cvt_pk_bf16_f32 v169, v18, v19
  v_cvt_pk_bf16_f32 v170, v20, v21
  v_mfma_f32_32x32x16_bf16 v[112:127], a[204:207], a[28:31], v[112:127]
  s_add_u32 s42, s39, s37
  s_add_u32 s39, s39, 24576
  s_cmp_eq_u32 s39, 147456
  s_cselect_b32 s39, 0, s39
  v_add_u32 v204, s39, v212
  v_xor_b32 v205, 32, v204
  v_xor_b32 v206, 64, v204
  v_xor_b32 v207, 96, v204
  v_add_u32 v198, s39, v213
  v_xor_b32 v199, 48, v198
  v_xor_b32 v244, 64, v223
  s_waitcnt vmcnt(24) lgkmcnt(0)
  s_barrier
  ds_read_b64_tr_b16 a[176:177], v204 offset:0
  ds_read_b64_tr_b16 a[178:179], v205 offset:3072
  ds_read_b64_tr_b16 a[180:181], v206 offset:0
  ds_read_b64_tr_b16 a[182:183], v207 offset:3072
  v_cvt_pk_bf16_f32 v171, v22, v23
  v_cvt_pk_bf16_f32 v172, v24, v25
  v_cvt_pk_bf16_f32 v173, v26, v27
  v_cvt_pk_bf16_f32 v174, v28, v29
  v_cvt_pk_bf16_f32 v175, v30, v31
  v_mfma_f32_32x32x16_bf16 v[112:127], a[208:211], a[32:35], v[112:127]
  ds_read_b64_tr_b16 a[184:185], v204 offset:128
  ds_read_b64_tr_b16 a[186:187], v205 offset:3200
  ds_read_b64_tr_b16 a[188:189], v206 offset:128
  ds_read_b64_tr_b16 a[190:191], v207 offset:3200
  v_max3_f32 v218, v96, v97, v98
  v_max3_f32 v218, v218, v99, v100
  v_max3_f32 v218, v218, v101, v102
  ds_read_b128 v[232:235], v225 offset:256
  s_mov_b32 s44, 98304
  v_mfma_f32_32x32x16_bf16 v[112:127], a[212:215], a[36:39], v[112:127]
  ds_read_b128 a[248:251], v223 offset:0
  ds_read_b128 a[252:255], v244 offset:0
  v_xor_b32 v223, 0x800, v223
  ds_read_b64_tr_b16 a[224:225], v198 offset:0
  ds_read_b64_tr_b16 a[226:227], v199 offset:1536
  v_max3_f32 v218, v218, v103, v104
  v_max3_f32 v218, v218, v105, v106
  v_max3_f32 v218, v218, v107, v108
  v_mfma_f32_32x32x16_bf16 v[112:127], a[216:219], a[40:43], v[112:127]
  ds_read_b64_tr_b16 a[192:193], v204 offset:256
  ds_read_b64_tr_b16 a[194:195], v205 offset:3328
  v_max3_f32 v218, v218, v109, v110
  v_max_f32 v218, v218, v111
  s_add_u32 m0, s42, 0
  v_mfma_f32_32x32x16_bf16 v[112:127], a[220:223], a[44:47], v[112:127]
  ds_read_b64_tr_b16 a[196:197], v206 offset:256
  ds_read_b64_tr_b16 a[198:199], v207 offset:3328
  s_waitcnt lgkmcnt(13)
  v_mfma_f32_32x32x16_bf16 v[0:15], a[176:179], v[160:163], 0
  ds_read_b64_tr_b16 a[200:201], v204 offset:6144
  ds_read_b64_tr_b16 a[202:203], v205 offset:9216
  v_mfma_f32_32x32x16_bf16 v[16:31], a[180:183], v[160:163], 0
  ds_read_b64_tr_b16 a[204:205], v206 offset:6144
  ds_read_b64_tr_b16 a[206:207], v207 offset:9216
  s_nop 2
  v_max3_f32 v218, v218, v112, v113
  v_max3_f32 v218, v218, v114, v115
  v_max3_f32 v218, v218, v116, v117
  buffer_load_dwordx4 v192, s[12:15], s44 offen offset:0 nt lds
  s_waitcnt lgkmcnt(13)
  v_mfma_f32_32x32x16_bf16 v[32:47], a[184:187], v[160:163], 0
  ds_read_b64_tr_b16 a[228:229], v198 offset:128
  ds_read_b64_tr_b16 a[230:231], v199 offset:1664
  v_max3_f32 v218, v218, v118, v119
  v_max3_f32 v218, v218, v120, v121
  v_max3_f32 v218, v218, v122, v123
  v_mfma_f32_32x32x16_bf16 v[48:63], a[188:191], v[160:163], 0
  ds_read_b64_tr_b16 a[208:209], v204 offset:6272
  ds_read_b64_tr_b16 a[210:211], v205 offset:9344
  v_max3_f32 v218, v218, v124, v125
  v_max3_f32 v218, v218, v126, v127
  v_mov_b32 v228, v218
  s_waitcnt lgkmcnt(15)
  v_max3_f32 v232, v232, v233, v234
  buffer_load_dwordx4 v193, s[12:15], s44 offen offset:1024 nt lds
  s_waitcnt lgkmcnt(10)
  v_mfma_f32_16x16x32_bf16 v[176:179], a[224:227], a[248:251], 0
  ds_read_b64_tr_b16 a[212:213], v206 offset:6272
  ds_read_b64_tr_b16 a[214:215], v207 offset:9344
  v_permlane32_swap_b32 v228, v218
  v_max_f32 v218, v218, v228
  v_add_f32 v228, s48, v214
  v_max_f32 v232, v232, v235
  v_mfma_f32_32x32x16_bf16 v[64:79], a[192:195], v[160:163], 0
  ds_read_b64_tr_b16 a[216:217], v204 offset:6400
  ds_read_b64_tr_b16 a[218:219], v205 offset:9472
  v_cmp_gt_f32 s[50:51], v218, v228
  v_mov_b32 v229, v215
  s_nop 0
  v_cndmask_b32 v214, v214, v218, s[50:51]
  v_mul_f32 v232, s47, v232
  s_waitcnt lgkmcnt(10)
  v_mfma_f32_32x32x16_bf16 v[80:95], a[196:199], v[160:163], 0
  ds_read_b64_tr_b16 a[220:221], v206 offset:6400
  ds_read_b64_tr_b16 a[222:223], v207 offset:9472
  v_mul_f32 v215, s47, v214
  v_sub_f32 v217, v229, v215
  v_exp_f32 v217, v217
  v_max_f32 v232, v232, v219
  buffer_load_dwordx4 v194, s[12:15], s44 offen offset:2048 nt lds
  v_mfma_f32_32x32x16_bf16 v[0:15], a[200:203], v[164:167], v[0:15]
  ds_read_b64_tr_b16 a[232:233], v198 offset:256
  ds_read_b64_tr_b16 a[234:235], v199 offset:1792
  v_mul_f32 v216, v216, v217
  v_fma_f32 v96, v96, s47, -v215
  v_sub_f32 v221, v219, v232
  v_exp_f32 v221, v221
  s_waitcnt lgkmcnt(10)
  v_mfma_f32_32x32x16_bf16 v[16:31], a[204:207], v[164:167], v[16:31]
  ds_read_b64_tr_b16 a[176:177], v204 offset:12288
  ds_read_b64_tr_b16 a[178:179], v205 offset:15360
  v_exp_f32 v96, v96
  v_fma_f32 v97, v97, s47, -v215
  v_exp_f32 v97, v97
  v_mov_b32 v219, v232
  s_add_u32 m0, s42, 3072
  v_mfma_f32_16x16x32_bf16 v[180:183], a[228:231], a[248:251], 0
  ds_read_b64_tr_b16 a[180:181], v206 offset:12288
  ds_read_b64_tr_b16 a[182:183], v207 offset:15360
  v_add_f32 v216, v216, v96
  v_fma_f32 v98, v98, s47, -v215
  v_exp_f32 v98, v98
  v_mul_f32 v220, v220, v221
  s_waitcnt lgkmcnt(10)
  v_mfma_f32_32x32x16_bf16 v[32:47], a[208:211], v[164:167], v[32:47]
  ds_read_b64_tr_b16 a[184:185], v204 offset:12416
  ds_read_b64_tr_b16 a[186:187], v205 offset:15488
  v_add_f32 v216, v216, v97
  v_fma_f32 v99, v99, s47, -v215
  v_exp_f32 v99, v99
  v_fma_f32 v188, v188, s47, -v219
  v_mfma_f32_32x32x16_bf16 v[48:63], a[212:215], v[164:167], v[48:63]
  ds_read_b64_tr_b16 a[188:189], v206 offset:12416
  ds_read_b64_tr_b16 a[190:191], v207 offset:15488
  v_add_f32 v216, v216, v98
  v_fma_f32 v100, v100, s47, -v215
  v_exp_f32 v100, v100
  v_exp_f32 v188, v188
  v_fma_f32 v189, v189, s47, -v219
  buffer_load_dwordx4 v195, s[12:15], s44 offen offset:0 nt lds
  s_waitcnt lgkmcnt(10)
  v_mfma_f32_32x32x16_bf16 v[64:79], a[216:219], v[164:167], v[64:79]
  ds_read_b64_tr_b16 a[236:237], v198 offset:12288
  ds_read_b64_tr_b16 a[238:239], v199 offset:13824
  v_add_f32 v216, v216, v99
  v_fma_f32 v101, v101, s47, -v215
  v_exp_f32 v101, v101
  v_exp_f32 v189, v189
  v_mfma_f32_32x32x16_bf16 v[80:95], a[220:223], v[164:167], v[80:95]
  ds_read_b64_tr_b16 a[192:193], v204 offset:12544
  ds_read_b64_tr_b16 a[194:195], v205 offset:15616
  v_add_f32 v216, v216, v100
  v_add_f32 v216, v216, v101
  v_add_f32 v220, v220, v188
  buffer_load_dwordx4 v196, s[12:15], s44 offen offset:1024 nt lds
  s_waitcnt lgkmcnt(10)
  v_mfma_f32_16x16x32_bf16 v[184:187], a[232:235], a[248:251], 0
  ds_read_b64_tr_b16 a[196:197], v206 offset:12544
  ds_read_b64_tr_b16 a[198:199], v207 offset:15616
  v_fma_f32 v102, v102, s47, -v215
  v_exp_f32 v102, v102
  v_fma_f32 v103, v103, s47, -v215
  v_fma_f32 v190, v190, s47, -v219
  v_mfma_f32_32x32x16_bf16 v[0:15], a[176:179], v[168:171], v[0:15]
  ds_read_b64_tr_b16 a[200:201], v204 offset:18432
  ds_read_b64_tr_b16 a[202:203], v205 offset:21504
  v_exp_f32 v103, v103
  v_add_f32 v216, v216, v102
  v_fma_f32 v104, v104, s47, -v215
  v_exp_f32 v190, v190
  v_add_f32 v220, v220, v189
  s_mov_b32 s28, s16
  s_mov_b32 s29, s17
  s_waitcnt lgkmcnt(10)
  v_mfma_f32_32x32x16_bf16 v[16:31], a[180:183], v[168:171], v[16:31]
  ds_read_b64_tr_b16 a[204:205], v206 offset:18432
  ds_read_b64_tr_b16 a[206:207], v207 offset:21504
  v_exp_f32 v104, v104
  v_add_f32 v216, v216, v103
  v_fma_f32 v191, v191, s47, -v219
  buffer_load_dwordx4 v197, s[12:15], s44 offen offset:2048 nt lds
  s_mov_b32 s30, s18
  s_mov_b32 s32, s12
  v_mfma_f32_32x32x16_bf16 v[32:47], a[184:187], v[168:171], v[32:47]
  ds_read_b64_tr_b16 a[240:241], v198 offset:12416
  ds_read_b64_tr_b16 a[242:243], v199 offset:13952
  v_fma_f32 v105, v105, s47, -v215
  v_exp_f32 v105, v105
  v_add_f32 v216, v216, v104
  v_exp_f32 v191, v191
  s_mov_b32 s33, s13
  s_mov_b32 s34, s14
  s_waitcnt lgkmcnt(10)
  v_mfma_f32_32x32x16_bf16 v[48:63], a[188:191], v[168:171], v[48:63]
  ds_read_b64_tr_b16 a[208:209], v204 offset:18560
  ds_read_b64_tr_b16 a[210:211], v205 offset:21632
  v_fma_f32 v106, v106, s47, -v215
  v_exp_f32 v106, v106
  v_add_f32 v220, v220, v190
  s_mov_b32 s45, 1
  v_mfma_f32_16x16x32_bf16 v[176:179], a[236:239], a[252:255], v[176:179]
  ds_read_b64_tr_b16 a[212:213], v206 offset:18560
  ds_read_b64_tr_b16 a[214:215], v207 offset:21632
  v_add_f32 v216, v216, v105
  v_fma_f32 v107, v107, s47, -v215
  v_exp_f32 v107, v107
  v_add_f32 v220, v220, v191
  v_cvt_pk_bf16_f32 v232, v188, v189
  s_waitcnt lgkmcnt(10)
  v_mfma_f32_32x32x16_bf16 v[64:79], a[192:195], v[168:171], v[64:79]
  ds_read_b64_tr_b16 a[216:217], v204 offset:18688
  ds_read_b64_tr_b16 a[218:219], v205 offset:21760
  v_add_f32 v216, v216, v106
  v_fma_f32 v108, v108, s47, -v215
  v_cvt_pk_bf16_f32 v233, v190, v191
  v_mfma_f32_32x32x16_bf16 v[80:95], a[196:199], v[168:171], v[80:95]
LI0:
  ds_read_b64_tr_b16 a[220:221], v206 offset:18688
  ds_read_b64_tr_b16 a[222:223], v207 offset:21760
  v_exp_f32 v108, v108
  v_add_f32 v216, v216, v107
  v_fma_f32 v109, v109, s47, -v215
  ds_write_b64 v222, v[232:233] offset:0
  s_waitcnt lgkmcnt(11)
  v_mfma_f32_32x32x16_bf16 v[0:15], a[200:203], v[172:175], v[0:15]
  ds_read_b64_tr_b16 a[244:245], v198 offset:12544
  ds_read_b64_tr_b16 a[246:247], v199 offset:14080
  v_exp_f32 v109, v109
  v_add_f32 v216, v216, v108
  v_xor_b32 v222, 0x800, v222
  v_mfma_f32_32x32x16_bf16 v[16:31], a[204:207], v[172:175], v[16:31]
  v_fma_f32 v110, v110, s47, -v215
  v_exp_f32 v110, v110
  v_add_f32 v216, v216, v109
  s_waitcnt lgkmcnt(9)
  v_mfma_f32_16x16x32_bf16 v[180:183], a[240:243], a[252:255], v[180:183]
  v_fma_f32 v111, v111, s47, -v215
  v_exp_f32 v111, v111
  v_mfma_f32_32x32x16_bf16 v[32:47], a[208:211], v[172:175], v[32:47]
  s_add_u32 s42, s39, s37
  s_add_u32 s39, s39, 24576
  s_cmp_eq_u32 s39, 147456
  s_cselect_b32 s39, 0, s39
  v_add_u32 v200, s39, v210
  v_xor_b32 v201, 32, v200
  v_xor_b32 v202, 64, v200
  v_xor_b32 v203, 96, v200
  v_add_u32 v208, s39, v211
  v_xor_b32 v209, 64, v208
  s_waitcnt vmcnt(24) lgkmcnt(0)
  s_barrier
  ds_read_b128 a[176:179], v200 offset:0
  ds_read_b128 a[180:183], v201 offset:0
  v_add_f32 v216, v216, v110
  v_add_f32 v216, v216, v111
  v_cvt_pk_bf16_f32 v160, v96, v97
  s_add_u32 s43, s43, 24576
  s_add_u32 s44, s44, 24576
  s_cmp_eq_u32 s45, 4
  s_cbranch_scc1 XG40
YG40:
  v_mfma_f32_32x32x16_bf16 v[48:63], a[212:215], v[172:175], v[48:63]
  ds_read_b128 a[184:187], v202 offset:0
  ds_read_b128 a[224:227], v208 offset:0
  v_cvt_pk_bf16_f32 v161, v98, v99
  v_cvt_pk_bf16_f32 v162, v100, v101
  s_cmp_eq_u32 s45, 5
  s_cbranch_scc1 XG50
YG50:
  s_cmp_eq_u32 s45, 6
  s_cbranch_scc1 XG60
YG60:
  v_mfma_f32_32x32x16_bf16 v[64:79], a[216:219], v[172:175], v[64:79]
  ds_read_b128 a[188:191], v203 offset:0
  v_cvt_pk_bf16_f32 v163, v102, v103
  v_cvt_pk_bf16_f32 v164, v104, v105
  v_cvt_pk_bf16_f32 v165, v106, v107
  v_mfma_f32_32x32x16_bf16 v[80:95], a[220:223], v[172:175], v[80:95]
  ds_read_b128 a[192:195], v200 offset:128
  v_cvt_pk_bf16_f32 v166, v108, v109
  v_cvt_pk_bf16_f32 v167, v110, v111
  s_add_u32 m0, s42, 0
  v_mfma_f32_16x16x32_bf16 v[184:187], a[244:247], a[252:255], v[184:187]
  ds_read_b128 a[228:231], v209 offset:0
  v_fma_f32 v112, v112, s47, -v215
  v_exp_f32 v112, v112
  v_fma_f32 v113, v113, s47, -v215
  v_exp_f32 v113, v113
  s_waitcnt lgkmcnt(5)
  v_mfma_f32_32x32x16_bf16 v[96:111], a[176:179], a[0:3], 0
  ds_read_b128 a[196:199], v201 offset:128
  buffer_load_dwordx4 v192, s[28:31], s43 offen offset:0 nt lds
  v_add_f32 v216, v216, v112
  v_fma_f32 v114, v114, s47, -v215
  v_exp_f32 v114, v114
  v_add_f32 v216, v216, v113
  v_mfma_f32_32x32x16_bf16 v[96:111], a[180:183], a[4:7], v[96:111]
  ds_read_b128 a[200:203], v202 offset:128
  v_fma_f32 v115, v115, s47, -v215
  v_exp_f32 v115, v115
  v_add_f32 v216, v216, v114
  v_fma_f32 v116, v116, s47, -v215
  s_waitcnt lgkmcnt(5)
  v_mfma_f32_32x32x16_bf16 v[96:111], a[184:187], a[8:11], v[96:111]
  ds_read_b128 a[232:235], v208 offset:128
  v_exp_f32 v116, v116
  v_add_f32 v216, v216, v115
  v_fma_f32 v117, v117, s47, -v215
  v_mfma_f32_16x16x32_bf16 v[188:191], a[224:227], a[96:99], 0
  ds_read_b128 a[204:207], v203 offset:128
  buffer_load_dwordx4 v193, s[28:31], s43 offen offset:1024 nt lds
  v_exp_f32 v117, v117
  v_add_f32 v216, v216, v116
  v_fma_f32 v118, v118, s47, -v215
  v_exp_f32 v118, v118
  s_waitcnt lgkmcnt(5)
  v_mfma_f32_32x32x16_bf16 v[96:111], a[188:191], a[12:15], v[96:111]
  ds_read_b128 a[208:211], v200 offset:256
  v_add_f32 v216, v216, v117
  v_fma_f32 v119, v119, s47, -v215
  v_exp_f32 v119, v119
  v_add_f32 v216, v216, v118
  v_mfma_f32_32x32x16_bf16 v[96:111], a[192:195], a[16:19], v[96:111]
  ds_read_b128 a[236:239], v209 offset:128
  buffer_load_dwordx4 v194, s[28:31], s43 offen offset:2048 nt lds
  v_fma_f32 v120, v120, s47, -v215
  v_exp_f32 v120, v120
  v_add_f32 v216, v216, v119
  v_fma_f32 v121, v121, s47, -v215
  s_waitcnt lgkmcnt(5)
  v_mfma_f32_16x16x32_bf16 v[188:191], a[228:231], a[100:103], v[188:191]
  ds_read_b128 a[212:215], v201 offset:256
  v_exp_f32 v121, v121
  v_add_f32 v216, v216, v120
  v_fma_f32 v122, v122, s47, -v215
  v_mfma_f32_32x32x16_bf16 v[96:111], a[196:199], a[20:23], v[96:111]
  ds_read_b128 a[216:219], v202 offset:256
  v_exp_f32 v122, v122
  v_add_f32 v216, v216, v121
  v_fma_f32 v123, v123, s47, -v215
  v_exp_f32 v123, v123
  s_waitcnt lgkmcnt(5)
  v_mfma_f32_32x32x16_bf16 v[96:111], a[200:203], a[24:27], v[96:111]
  ds_read_b128 a[240:243], v208 offset:256
  s_add_u32 m0, s42, 3072
  v_add_f32 v216, v216, v122
  v_fma_f32 v124, v124, s47, -v215
  v_exp_f32 v124, v124
  v_add_f32 v216, v216, v123
  v_mfma_f32_16x16x32_bf16 v[188:191], a[232:235], a[104:107], v[188:191]
  ds_read_b128 a[220:223], v203 offset:256
  v_fma_f32 v125, v125, s47, -v215
  v_exp_f32 v125, v125
  v_add_f32 v216, v216, v124
  v_fma_f32 v126, v126, s47, -v215
  s_waitcnt lgkmcnt(5)
  v_mfma_f32_32x32x16_bf16 v[96:111], a[204:207], a[28:31], v[96:111]
  ds_read_b128 a[176:179], v200 offset:12288
  v_exp_f32 v126, v126
  v_add_f32 v216, v216, v125
  v_fma_f32 v127, v127, s47, -v215
  v_mfma_f32_32x32x16_bf16 v[96:111], a[208:211], a[32:35], v[96:111]
  ds_read_b128 a[244:247], v209 offset:256
  buffer_load_dwordx4 v195, s[28:31], s43 offen offset:0 nt lds
  v_exp_f32 v127, v127
  v_add_f32 v216, v216, v126
  v_add_f32 v216, v216, v127
  v_cvt_pk_bf16_f32 v168, v112, v113
  s_waitcnt lgkmcnt(5)
  v_mfma_f32_16x16x32_bf16 v[188:191], a[236:239], a[108:111], v[188:191]
  ds_read_b128 a[180:183], v201 offset:12288
  v_cvt_pk_bf16_f32 v169, v114, v115
  v_cvt_pk_bf16_f32 v170, v116, v117
  v_cvt_pk_bf16_f32 v171, v118, v119
  v_cvt_pk_bf16_f32 v172, v120, v121
  v_mfma_f32_32x32x16_bf16 v[96:111], a[212:215], a[36:39], v[96:111]
  ds_read_b128 a[184:187], v202 offset:12288
  buffer_load_dwordx4 v196, s[28:31], s43 offen offset:1024 nt lds
  v_cvt_pk_bf16_f32 v173, v122, v123
  v_cvt_pk_bf16_f32 v174, v124, v125
  v_cvt_pk_bf16_f32 v175, v126, v127
  s_waitcnt lgkmcnt(5)
  v_mfma_f32_32x32x16_bf16 v[96:111], a[216:219], a[40:43], v[96:111]
  ds_read_b128 a[188:191], v203 offset:12288
  v_mul_f32 v176, v176, v221
  v_mul_f32 v177, v177, v221
  v_mfma_f32_16x16x32_bf16 v[188:191], a[240:243], a[112:115], v[188:191]
  ds_read_b128 a[192:195], v200 offset:12416
  v_mul_f32 v178, v178, v221
  v_mul_f32 v179, v179, v221
  s_waitcnt lgkmcnt(5)
  v_mfma_f32_32x32x16_bf16 v[96:111], a[220:223], a[44:47], v[96:111]
  ds_read_b128 a[196:199], v201 offset:12416
  buffer_load_dwordx4 v197, s[28:31], s43 offen offset:2048 nt lds
  v_mul_f32 v180, v180, v221
  v_mul_f32 v181, v181, v221
  v_mfma_f32_32x32x16_bf16 v[112:127], a[176:179], a[0:3], 0
  ds_read_b128 a[200:203], v202 offset:12416
  v_mul_f32 v182, v182, v221
  v_mul_f32 v183, v183, v221
  s_waitcnt lgkmcnt(5)
  v_mfma_f32_16x16x32_bf16 v[188:191], a[244:247], a[116:119], v[188:191]
  ds_read_b128 a[204:207], v203 offset:12416
  v_mul_f32 v184, v184, v221
  v_mul_f32 v185, v185, v221
  v_mfma_f32_32x32x16_bf16 v[112:127], a[180:183], a[4:7], v[112:127]
  ds_read_b128 a[208:211], v200 offset:12544
  v_mul_f32 v186, v186, v221
  v_mul_f32 v187, v187, v221
  s_waitcnt lgkmcnt(5)
  v_mfma_f32_32x32x16_bf16 v[112:127], a[184:187], a[8:11], v[112:127]
  ds_read_b128 a[212:215], v201 offset:12544
  v_max3_f32 v230, v188, v189, v190
  v_max_f32 v230, v230, v191
  v_mfma_f32_32x32x16_bf16 v[112:127], a[188:191], a[12:15], v[112:127]
  ds_read_b128 a[216:219], v202 offset:12544
  v_mov_b32 v231, v230
  s_nop 1
  v_permlane16_swap_b32 v231, v230
  s_waitcnt lgkmcnt(5)
  v_mfma_f32_32x32x16_bf16 v[112:127], a[192:195], a[16:19], v[112:127]
  ds_read_b128 a[220:223], v203 offset:12544
  v_max_f32 v230, v230, v231
  v_mov_b32 v231, v230
  v_mfma_f32_32x32x16_bf16 v[112:127], a[196:199], a[20:23], v[112:127]
  s_nop 0
  v_permlane32_swap_b32 v231, v230
  v_max_f32 v230, v230, v231
  v_max3_f32 v218, v96, v97, v98
  v_max3_f32 v218, v218, v99, v100
  s_waitcnt lgkmcnt(4)
  v_mfma_f32_32x32x16_bf16 v[112:127], a[200:203], a[24:27], v[112:127]
  ds_write_b32 v224, v230 offset:256
  v_max3_f32 v218, v218, v101, v102
  v_mfma_f32_32x32x16_bf16 v[112:127], a[204:207], a[28:31], v[112:127]
  s_add_u32 s42, s39, s37
  s_add_u32 s39, s39, 24576
  s_cmp_eq_u32 s39, 147456
  s_cselect_b32 s39, 0, s39
  v_add_u32 v204, s39, v212
  v_xor_b32 v205, 32, v204
  v_xor_b32 v206, 64, v204
  v_xor_b32 v207, 96, v204
  v_add_u32 v198, s39, v213
  v_xor_b32 v199, 48, v198
  v_xor_b32 v244, 64, v223
  s_waitcnt vmcnt(24) lgkmcnt(0)
  s_barrier
  ds_read_b64_tr_b16 a[176:177], v204 offset:0
  ds_read_b64_tr_b16 a[178:179], v205 offset:3072
  ds_read_b64_tr_b16 a[180:181], v206 offset:0
  ds_read_b64_tr_b16 a[182:183], v207 offset:3072
  v_max3_f32 v218, v218, v103, v104
  v_mfma_f32_32x32x16_bf16 v[112:127], a[208:211], a[32:35], v[112:127]
  ds_read_b64_tr_b16 a[184:185], v204 offset:128
  ds_read_b64_tr_b16 a[186:187], v205 offset:3200
  ds_read_b64_tr_b16 a[188:189], v206 offset:128
  ds_read_b64_tr_b16 a[190:191], v207 offset:3200
  v_max3_f32 v218, v218, v105, v106
  v_max3_f32 v218, v218, v107, v108
  ds_read_b128 v[232:235], v225 offset:256
  s_add_u32 m0, s42, 0
  v_mfma_f32_32x32x16_bf16 v[112:127], a[212:215], a[36:39], v[112:127]
  ds_read_b128 a[248:251], v223 offset:0
  ds_read_b128 a[252:255], v244 offset:0
  v_xor_b32 v223, 0x800, v223
  ds_read_b64_tr_b16 a[224:225], v198 offset:0
  ds_read_b64_tr_b16 a[226:227], v199 offset:1536
  v_max3_f32 v218, v218, v109, v110
  v_mfma_f32_32x32x16_bf16 v[112:127], a[216:219], a[40:43], v[112:127]
  ds_read_b64_tr_b16 a[192:193], v204 offset:256
  ds_read_b64_tr_b16 a[194:195], v205 offset:3328
  v_max_f32 v218, v218, v111
  buffer_load_dwordx4 v192, s[32:35], s44 offen offset:0 nt lds
  v_mfma_f32_32x32x16_bf16 v[112:127], a[220:223], a[44:47], v[112:127]
  ds_read_b64_tr_b16 a[196:197], v206 offset:256
  ds_read_b64_tr_b16 a[198:199], v207 offset:3328
  s_cmp_lg_u64 s[50:51], 0
  s_cbranch_scc1 RARE0
RET0:
  s_waitcnt lgkmcnt(13)
  v_mfma_f32_32x32x16_bf16 v[0:15], a[176:179], v[160:163], v[0:15]
  ds_read_b64_tr_b16 a[200:201], v204 offset:6144
  ds_read_b64_tr_b16 a[202:203], v205 offset:9216
  v_mfma_f32_32x32x16_bf16 v[16:31], a[180:183], v[160:163], v[16:31]
  ds_read_b64_tr_b16 a[204:205], v206 offset:6144
  ds_read_b64_tr_b16 a[206:207], v207 offset:9216
  s_nop 0
  v_max3_f32 v218, v218, v112, v113
  v_max3_f32 v218, v218, v114, v115
  v_max3_f32 v218, v218, v116, v117
  buffer_load_dwordx4 v193, s[32:35], s44 offen offset:1024 nt lds
  s_waitcnt lgkmcnt(13)
  v_mfma_f32_32x32x16_bf16 v[32:47], a[184:187], v[160:163], v[32:47]
  ds_read_b64_tr_b16 a[228:229], v198 offset:128
  ds_read_b64_tr_b16 a[230:231], v199 offset:1664
  v_max3_f32 v218, v218, v118, v119
  v_max3_f32 v218, v218, v120, v121
  v_max3_f32 v218, v218, v122, v123
  v_mfma_f32_32x32x16_bf16 v[48:63], a[188:191], v[160:163], v[48:63]
  ds_read_b64_tr_b16 a[208:209], v204 offset:6272
  ds_read_b64_tr_b16 a[210:211], v205 offset:9344
  v_max3_f32 v218, v218, v124, v125
  v_max3_f32 v218, v218, v126, v127
  v_mov_b32 v228, v218
  s_waitcnt lgkmcnt(15)
  v_max3_f32 v232, v232, v233, v234
  s_waitcnt lgkmcnt(10)
  v_mfma_f32_16x16x32_bf16 v[176:179], a[224:227], a[248:251], v[176:179]
  ds_read_b64_tr_b16 a[212:213], v206 offset:6272
  ds_read_b64_tr_b16 a[214:215], v207 offset:9344
  v_permlane32_swap_b32 v228, v218
  v_max_f32 v218, v218, v228
  v_add_f32 v228, s48, v214
  v_max_f32 v232, v232, v235
  buffer_load_dwordx4 v194, s[32:35], s44 offen offset:2048 nt lds
  v_mfma_f32_32x32x16_bf16 v[64:79], a[192:195], v[160:163], v[64:79]
  ds_read_b64_tr_b16 a[216:217], v204 offset:6400
  ds_read_b64_tr_b16 a[218:219], v205 offset:9472
  v_cmp_gt_f32 s[50:51], v218, v228
  v_mov_b32 v229, v215
  s_nop 0
  v_cndmask_b32 v214, v214, v218, s[50:51]
  v_mul_f32 v232, s47, v232
  s_waitcnt lgkmcnt(10)
  v_mfma_f32_32x32x16_bf16 v[80:95], a[196:199], v[160:163], v[80:95]
  ds_read_b64_tr_b16 a[220:221], v206 offset:6400
  ds_read_b64_tr_b16 a[222:223], v207 offset:9472
  v_mul_f32 v215, s47, v214
  v_sub_f32 v217, v229, v215
  v_exp_f32 v217, v217
  v_max_f32 v232, v232, v219
  v_mfma_f32_32x32x16_bf16 v[0:15], a[200:203], v[164:167], v[0:15]
  ds_read_b64_tr_b16 a[232:233], v198 offset:256
  ds_read_b64_tr_b16 a[234:235], v199 offset:1792
  v_mul_f32 v216, v216, v217
  v_fma_f32 v96, v96, s47, -v215
  v_sub_f32 v221, v219, v232
  v_exp_f32 v221, v221
  s_add_u32 m0, s42, 3072
  s_waitcnt lgkmcnt(10)
  v_mfma_f32_32x32x16_bf16 v[16:31], a[204:207], v[164:167], v[16:31]
  ds_read_b64_tr_b16 a[176:177], v204 offset:12288
  ds_read_b64_tr_b16 a[178:179], v205 offset:15360
  v_exp_f32 v96, v96
  v_fma_f32 v97, v97, s47, -v215
  v_exp_f32 v97, v97
  v_mov_b32 v219, v232
  v_mfma_f32_16x16x32_bf16 v[180:183], a[228:231], a[248:251], v[180:183]
  ds_read_b64_tr_b16 a[180:181], v206 offset:12288
  ds_read_b64_tr_b16 a[182:183], v207 offset:15360
  v_add_f32 v216, v216, v96
  v_fma_f32 v98, v98, s47, -v215
  v_exp_f32 v98, v98
  v_mul_f32 v220, v220, v221
  s_waitcnt lgkmcnt(10)
  v_mfma_f32_32x32x16_bf16 v[32:47], a[208:211], v[164:167], v[32:47]
  ds_read_b64_tr_b16 a[184:185], v204 offset:12416
  ds_read_b64_tr_b16 a[186:187], v205 offset:15488
  v_add_f32 v216, v216, v97
  v_fma_f32 v99, v99, s47, -v215
  v_exp_f32 v99, v99
  v_fma_f32 v188, v188, s47, -v219
  buffer_load_dwordx4 v195, s[32:35], s44 offen offset:0 nt lds
  v_mfma_f32_32x32x16_bf16 v[48:63], a[212:215], v[164:167], v[48:63]
  ds_read_b64_tr_b16 a[188:189], v206 offset:12416
  ds_read_b64_tr_b16 a[190:191], v207 offset:15488
  v_add_f32 v216, v216, v98
  v_fma_f32 v100, v100, s47, -v215
  v_exp_f32 v100, v100
  v_exp_f32 v188, v188
  v_fma_f32 v189, v189, s47, -v219
  s_waitcnt lgkmcnt(10)
  v_mfma_f32_32x32x16_bf16 v[64:79], a[216:219], v[164:167], v[64:79]
  ds_read_b64_tr_b16 a[236:237], v198 offset:12288
  ds_read_b64_tr_b16 a[238:239], v199 offset:13824
  v_add_f32 v216, v216, v99
  v_fma_f32 v101, v101, s47, -v215
  v_exp_f32 v101, v101
  v_exp_f32 v189, v189
  v_mfma_f32_32x32x16_bf16 v[80:95], a[220:223], v[164:167], v[80:95]
  ds_read_b64_tr_b16 a[192:193], v204 offset:12544
  ds_read_b64_tr_b16 a[194:195], v205 offset:15616
  v_add_f32 v216, v216, v100
  v_add_f32 v216, v216, v101
  v_add_f32 v220, v220, v188
  buffer_load_dwordx4 v196, s[32:35], s44 offen offset:1024 nt lds
  s_waitcnt lgkmcnt(10)
  v_mfma_f32_16x16x32_bf16 v[184:187], a[232:235], a[248:251], v[184:187]
  ds_read_b64_tr_b16 a[196:197], v206 offset:12544
  ds_read_b64_tr_b16 a[198:199], v207 offset:15616
  v_fma_f32 v102, v102, s47, -v215
  v_exp_f32 v102, v102
  v_fma_f32 v103, v103, s47, -v215
  v_fma_f32 v190, v190, s47, -v219
  v_mfma_f32_32x32x16_bf16 v[0:15], a[176:179], v[168:171], v[0:15]
  ds_read_b64_tr_b16 a[200:201], v204 offset:18432
  ds_read_b64_tr_b16 a[202:203], v205 offset:21504
  v_exp_f32 v103, v103
  v_add_f32 v216, v216, v102
  v_fma_f32 v104, v104, s47, -v215
  v_exp_f32 v190, v190
  v_add_f32 v220, v220, v189
  s_waitcnt lgkmcnt(10)
  v_mfma_f32_32x32x16_bf16 v[16:31], a[180:183], v[168:171], v[16:31]
  ds_read_b64_tr_b16 a[204:205], v206 offset:18432
  ds_read_b64_tr_b16 a[206:207], v207 offset:21504
  v_exp_f32 v104, v104
  v_add_f32 v216, v216, v103
  v_fma_f32 v191, v191, s47, -v219
  buffer_load_dwordx4 v197, s[32:35], s44 offen offset:2048 nt lds
  v_mfma_f32_32x32x16_bf16 v[32:47], a[184:187], v[168:171], v[32:47]
  ds_read_b64_tr_b16 a[240:241], v198 offset:12416
  ds_read_b64_tr_b16 a[242:243], v199 offset:13952
  v_fma_f32 v105, v105, s47, -v215
  v_exp_f32 v105, v105
  v_add_f32 v216, v216, v104
  v_exp_f32 v191, v191
  s_waitcnt lgkmcnt(10)
  v_mfma_f32_32x32x16_bf16 v[48:63], a[188:191], v[168:171], v[48:63]
  ds_read_b64_tr_b16 a[208:209], v204 offset:18560
  ds_read_b64_tr_b16 a[210:211], v205 offset:21632
  v_fma_f32 v106, v106, s47, -v215
  v_exp_f32 v106, v106
  v_add_f32 v220, v220, v190
  v_mfma_f32_16x16x32_bf16 v[176:179], a[236:239], a[252:255], v[176:179]
  ds_read_b64_tr_b16 a[212:213], v206 offset:18560
  ds_read_b64_tr_b16 a[214:215], v207 offset:21632
  v_add_f32 v216, v216, v105
  v_fma_f32 v107, v107, s47, -v215
  v_exp_f32 v107, v107
  v_add_f32 v220, v220, v191
  v_cvt_pk_bf16_f32 v232, v188, v189
  s_waitcnt lgkmcnt(10)
  v_mfma_f32_32x32x16_bf16 v[64:79], a[192:195], v[168:171], v[64:79]
  ds_read_b64_tr_b16 a[216:217], v204 offset:18688
  ds_read_b64_tr_b16 a[218:219], v205 offset:21760
  v_add_f32 v216, v216, v106
  v_fma_f32 v108, v108, s47, -v215
  v_cvt_pk_bf16_f32 v233, v190, v191
  v_mfma_f32_32x32x16_bf16 v[80:95], a[196:199], v[168:171], v[80:95]
  s_add_u32 s45, s45, 1
  s_cmp_lg_u32 s45, 7
  s_cbranch_scc1 LI0
  ds_read_b64_tr_b16 a[220:221], v206 offset:18688
  ds_read_b64_tr_b16 a[222:223], v207 offset:21760
  v_exp_f32 v108, v108
  v_add_f32 v216, v216, v107
  v_fma_f32 v109, v109, s47, -v215
  ds_write_b64 v222, v[232:233] offset:0
  s_waitcnt lgkmcnt(11)
  v_mfma_f32_32x32x16_bf16 v[0:15], a[200:203], v[172:175], v[0:15]
  ds_read_b64_tr_b16 a[244:245], v198 offset:12544
  ds_read_b64_tr_b16 a[246:247], v199 offset:14080
  v_exp_f32 v109, v109
  v_add_f32 v216, v216, v108
  v_xor_b32 v222, 0x800, v222
  v_mfma_f32_32x32x16_bf16 v[16:31], a[204:207], v[172:175], v[16:31]
  v_fma_f32 v110, v110, s47, -v215
  v_exp_f32 v110, v110
  v_add_f32 v216, v216, v109
  s_waitcnt lgkmcnt(9)
  v_mfma_f32_16x16x32_bf16 v[180:183], a[240:243], a[252:255], v[180:183]
  v_fma_f32 v111, v111, s47, -v215
  v_exp_f32 v111, v111
  v_mfma_f32_32x32x16_bf16 v[32:47], a[208:211], v[172:175], v[32:47]
  s_add_u32 s42, s39, s37
  s_add_u32 s39, s39, 24576
  s_cmp_eq_u32 s39, 147456
  s_cselect_b32 s39, 0, s39
  v_add_u32 v204, s39, v212
  v_xor_b32 v205, 32, v204
  v_xor_b32 v206, 64, v204
  v_xor_b32 v207, 96, v204
  v_add_u32 v198, s39, v213
  v_xor_b32 v199, 48, v198
  v_xor_b32 v244, 64, v223
  s_waitcnt vmcnt(24) lgkmcnt(0)
  s_barrier
  ds_read_b64_tr_b16 a[176:177], v204 offset:0
  ds_read_b64_tr_b16 a[178:179], v205 offset:3072
  ds_read_b64_tr_b16 a[180:181], v206 offset:0
  ds_read_b64_tr_b16 a[182:183], v207 offset:3072
  v_add_f32 v216, v216, v110
  v_add_f32 v216, v216, v111
  v_cvt_pk_bf16_f32 v160, v96, v97
  v_mfma_f32_32x32x16_bf16 v[48:63], a[212:215], v[172:175], v[48:63]
  ds_read_b64_tr_b16 a[184:185], v204 offset:128
  ds_read_b64_tr_b16 a[186:187], v205 offset:3200
  ds_read_b64_tr_b16 a[188:189], v206 offset:128
  ds_read_b64_tr_b16 a[190:191], v207 offset:3200
  v_cvt_pk_bf16_f32 v161, v98, v99
  v_cvt_pk_bf16_f32 v162, v100, v101
  s_mov_b32 s43, 221184
  v_mfma_f32_32x32x16_bf16 v[64:79], a[216:219], v[172:175], v[64:79]
  ds_read_b64_tr_b16 a[192:193], v204 offset:256
  ds_read_b64_tr_b16 a[194:195], v205 offset:3328
  v_cvt_pk_bf16_f32 v163, v102, v103
  v_cvt_pk_bf16_f32 v164, v104, v105
  v_cvt_pk_bf16_f32 v165, v106, v107
  v_mfma_f32_32x32x16_bf16 v[80:95], a[220:223], v[172:175], v[80:95]
  ds_read_b64_tr_b16 a[196:197], v206 offset:256
  ds_read_b64_tr_b16 a[198:199], v207 offset:3328
  v_cvt_pk_bf16_f32 v166, v108, v109
  v_cvt_pk_bf16_f32 v167, v110, v111
  s_add_u32 m0, s42, 0
  v_mfma_f32_16x16x32_bf16 v[184:187], a[244:247], a[252:255], v[184:187]
  ds_read_b64_tr_b16 a[200:201], v204 offset:6144
  ds_read_b64_tr_b16 a[202:203], v205 offset:9216
  v_fma_f32 v112, v112, s47, -v215
  v_exp_f32 v112, v112
  v_fma_f32 v113, v113, s47, -v215
  v_exp_f32 v113, v113
  v_add_f32 v216, v216, v112
  s_cmp_lg_u64 s[50:51], 0
  s_cbranch_scc1 RARE0_7
RET0_7:
  s_waitcnt lgkmcnt(10)
  v_mfma_f32_32x32x16_bf16 v[0:15], a[176:179], v[160:163], v[0:15]
  ds_read_b64_tr_b16 a[204:205], v206 offset:6144
  ds_read_b64_tr_b16 a[206:207], v207 offset:9216
  v_fma_f32 v114, v114, s47, -v215
  v_exp_f32 v114, v114
  v_add_f32 v216, v216, v113
  v_fma_f32 v115, v115, s47, -v215
  v_exp_f32 v115, v115
  v_mfma_f32_32x32x16_bf16 v[16:31], a[180:183], v[160:163], v[16:31]
  ds_read_b64_tr_b16 a[208:209], v204 offset:6272
  ds_read_b64_tr_b16 a[210:211], v205 offset:9344
  buffer_load_dwordx4 v192, s[16:19], s43 offen offset:0 nt lds
  v_add_f32 v216, v216, v114
  v_fma_f32 v116, v116, s47, -v215
  v_exp_f32 v116, v116
  v_add_f32 v216, v216, v115
  s_waitcnt lgkmcnt(10)
  v_mfma_f32_32x32x16_bf16 v[32:47], a[184:187], v[160:163], v[32:47]
  ds_read_b64_tr_b16 a[212:213], v206 offset:6272
  ds_read_b64_tr_b16 a[214:215], v207 offset:9344
  v_fma_f32 v117, v117, s47, -v215
  v_exp_f32 v117, v117
  v_add_f32 v216, v216, v116
  v_fma_f32 v118, v118, s47, -v215
  v_exp_f32 v118, v118
  v_mfma_f32_32x32x16_bf16 v[48:63], a[188:191], v[160:163], v[48:63]
  ds_read_b64_tr_b16 a[216:217], v204 offset:6400
  ds_read_b64_tr_b16 a[218:219], v205 offset:9472
  buffer_load_dwordx4 v193, s[16:19], s43 offen offset:1024 nt lds
  v_add_f32 v216, v216, v117
  v_fma_f32 v119, v119, s47, -v215
  v_exp_f32 v119, v119
  v_add_f32 v216, v216, v118
  v_fma_f32 v120, v120, s47, -v215
  v_mul_f32 v176, v176, v221
  v_mul_f32 v177, v177, v221
  s_waitcnt lgkmcnt(10)
  v_mfma_f32_32x32x16_bf16 v[64:79], a[192:195], v[160:163], v[64:79]
  ds_read_b64_tr_b16 a[220:221], v206 offset:6400
  ds_read_b64_tr_b16 a[222:223], v207 offset:9472
  v_exp_f32 v120, v120
  v_add_f32 v216, v216, v119
  v_fma_f32 v121, v121, s47, -v215
  v_exp_f32 v121, v121
  v_mul_f32 v178, v178, v221
  v_mfma_f32_32x32x16_bf16 v[80:95], a[196:199], v[160:163], v[80:95]
  ds_read_b64_tr_b16 a[176:177], v204 offset:12288
  ds_read_b64_tr_b16 a[178:179], v205 offset:15360
  v_add_f32 v216, v216, v120
  v_fma_f32 v122, v122, s47, -v215
  v_exp_f32 v122, v122
  v_add_f32 v216, v216, v121
  v_fma_f32 v123, v123, s47, -v215
  v_mul_f32 v179, v179, v221
  v_mul_f32 v180, v180, v221
  s_waitcnt lgkmcnt(10)
  v_mfma_f32_32x32x16_bf16 v[0:15], a[200:203], v[164:167], v[0:15]
  ds_read_b128 a[248:251], v223 offset:0
  ds_read_b128 a[252:255], v244 offset:0
  v_xor_b32 v223, 0x800, v223
  ds_read_b64_tr_b16 a[224:225], v198 offset:0
  ds_read_b64_tr_b16 a[226:227], v199 offset:1536
  buffer_load_dwordx4 v194, s[16:19], s43 offen offset:2048 nt lds
  v_exp_f32 v123, v123
  v_add_f32 v216, v216, v122
  v_fma_f32 v124, v124, s47, -v215
  v_exp_f32 v124, v124
  v_add_f32 v216, v216, v123
  v_mul_f32 v181, v181, v221
  v_mfma_f32_32x32x16_bf16 v[16:31], a[204:207], v[164:167], v[16:31]
  ds_read_b64_tr_b16 a[180:181], v206 offset:12288
  ds_read_b64_tr_b16 a[182:183], v207 offset:15360
  v_fma_f32 v125, v125, s47, -v215
  v_exp_f32 v125, v125
  v_add_f32 v216, v216, v124
  v_fma_f32 v126, v126, s47, -v215
  v_mul_f32 v182, v182, v221
  v_mul_f32 v183, v183, v221
  s_waitcnt lgkmcnt(12)
  v_mfma_f32_32x32x16_bf16 v[32:47], a[208:211], v[164:167], v[32:47]
  ds_read_b64_tr_b16 a[184:185], v204 offset:12416
  ds_read_b64_tr_b16 a[186:187], v205 offset:15488
  s_add_u32 m0, s42, 3072
  v_exp_f32 v126, v126
  v_add_f32 v216, v216, v125
  v_fma_f32 v127, v127, s47, -v215
  v_exp_f32 v127, v127
  v_add_f32 v216, v216, v126
  v_mul_f32 v184, v184, v221
  v_mfma_f32_32x32x16_bf16 v[48:63], a[212:215], v[164:167], v[48:63]
  ds_read_b64_tr_b16 a[228:229], v198 offset:128
  ds_read_b64_tr_b16 a[230:231], v199 offset:1664
  v_add_f32 v216, v216, v127
  v_cvt_pk_bf16_f32 v168, v112, v113
  v_cvt_pk_bf16_f32 v169, v114, v115
  v_cvt_pk_bf16_f32 v170, v116, v117
  v_cvt_pk_bf16_f32 v171, v118, v119
  v_mul_f32 v185, v185, v221
  v_mul_f32 v186, v186, v221
  s_waitcnt lgkmcnt(12)
  v_mfma_f32_32x32x16_bf16 v[64:79], a[216:219], v[164:167], v[64:79]
  ds_read_b64_tr_b16 a[188:189], v206 offset:12416
  ds_read_b64_tr_b16 a[190:191], v207 offset:15488
  v_cvt_pk_bf16_f32 v172, v120, v121
  v_cvt_pk_bf16_f32 v173, v122, v123
  v_cvt_pk_bf16_f32 v174, v124, v125
  v_cvt_pk_bf16_f32 v175, v126, v127
  v_mul_f32 v187, v187, v221
  v_mfma_f32_32x32x16_bf16 v[80:95], a[220:223], v[164:167], v[80:95]
  ds_read_b64_tr_b16 a[192:193], v204 offset:12544
  ds_read_b64_tr_b16 a[194:195], v205 offset:15616
  buffer_load_dwordx4 v195, s[16:19], s43 offen offset:0 nt lds
  s_waitcnt lgkmcnt(10)
  v_mfma_f32_32x32x16_bf16 v[0:15], a[176:179], v[168:171], v[0:15]
  ds_read_b64_tr_b16 a[232:233], v198 offset:256
  ds_read_b64_tr_b16 a[234:235], v199 offset:1792
  v_mfma_f32_16x16x32_bf16 v[176:179], a[224:227], a[248:251], v[176:179]
  ds_read_b64_tr_b16 a[196:197], v206 offset:12544
  ds_read_b64_tr_b16 a[198:199], v207 offset:15616
  buffer_load_dwordx4 v196, s[16:19], s43 offen offset:1024 nt lds
  v_mov_b32 v231, v220
  s_nop 1
  v_permlane16_swap_b32 v231, v220
  s_waitcnt lgkmcnt(10)
  v_mfma_f32_32x32x16_bf16 v[16:31], a[180:183], v[168:171], v[16:31]
  ds_read_b64_tr_b16 a[200:201], v204 offset:18432
  ds_read_b64_tr_b16 a[202:203], v205 offset:21504
  v_add_f32 v220, v220, v231
  v_mfma_f32_32x32x16_bf16 v[32:47], a[184:187], v[168:171], v[32:47]
  ds_read_b64_tr_b16 a[236:237], v198 offset:12288
  ds_read_b64_tr_b16 a[238:239], v199 offset:13824
  v_mov_b32 v231, v220
  s_waitcnt lgkmcnt(10)
  v_mfma_f32_16x16x32_bf16 v[180:183], a[228:231], a[248:251], v[180:183]
  ds_read_b64_tr_b16 a[204:205], v206 offset:18432
  ds_read_b64_tr_b16 a[206:207], v207 offset:21504
  buffer_load_dwordx4 v197, s[16:19], s43 offen offset:2048 nt lds
  v_permlane32_swap_b32 v231, v220
  v_mfma_f32_32x32x16_bf16 v[48:63], a[188:191], v[168:171], v[48:63]
  ds_read_b64_tr_b16 a[208:209], v204 offset:18560
  ds_read_b64_tr_b16 a[210:211], v205 offset:21632
  v_add_f32 v220, v220, v231
  s_waitcnt lgkmcnt(10)
  v_mfma_f32_32x32x16_bf16 v[64:79], a[192:195], v[168:171], v[64:79]
  ds_read_b64_tr_b16 a[240:241], v198 offset:12416
  ds_read_b64_tr_b16 a[242:243], v199 offset:13952
  ds_write_b32 v224, v220 offset:512
  v_mfma_f32_16x16x32_bf16 v[184:187], a[232:235], a[248:251], v[184:187]
  ds_read_b64_tr_b16 a[212:213], v206 offset:18560
  ds_read_b64_tr_b16 a[214:215], v207 offset:21632
  v_mov_b32 v228, v216
  s_waitcnt lgkmcnt(11)
  v_mfma_f32_32x32x16_bf16 v[80:95], a[196:199], v[168:171], v[80:95]
  ds_read_b64_tr_b16 a[216:217], v204 offset:18688
  ds_read_b64_tr_b16 a[218:219], v205 offset:21760
  v_permlane32_swap_b32 v228, v216
  v_mfma_f32_32x32x16_bf16 v[0:15], a[200:203], v[172:175], v[0:15]
  ds_read_b64_tr_b16 a[244:245], v198 offset:12544
  ds_read_b64_tr_b16 a[246:247], v199 offset:14080
  v_add_f32 v216, v216, v228
  s_waitcnt lgkmcnt(11)
  v_mfma_f32_16x16x32_bf16 v[176:179], a[236:239], a[252:255], v[176:179]
  ds_read_b64_tr_b16 a[220:221], v206 offset:18688
  ds_read_b64_tr_b16 a[222:223], v207 offset:21760
  v_rcp_f32 v217, v216
  v_mfma_f32_32x32x16_bf16 v[16:31], a[204:207], v[172:175], v[16:31]
  s_waitcnt lgkmcnt(9)
  v_mfma_f32_32x32x16_bf16 v[32:47], a[208:211], v[172:175], v[32:47]
  v_mfma_f32_16x16x32_bf16 v[180:183], a[240:243], a[252:255], v[180:183]
  s_add_u32 s42, s39, s37
  s_add_u32 s39, s39, 24576
  s_cmp_eq_u32 s39, 147456
  s_cselect_b32 s39, 0, s39
  v_add_u32 v200, s39, v210
  v_xor_b32 v201, 32, v200
  v_xor_b32 v202, 64, v200
  v_xor_b32 v203, 96, v200
  v_add_u32 v208, s39, v211
  v_xor_b32 v209, 64, v208
  v_xor_b32 v244, 64, v227
  s_waitcnt vmcnt(24) lgkmcnt(0)
  s_barrier
  ds_read_b128 a[176:179], v200 offset:0
  ds_read_b128 a[180:183], v201 offset:0
  v_mfma_f32_32x32x16_bf16 v[48:63], a[212:215], v[172:175], v[48:63]
  ds_read_b128 a[184:187], v202 offset:0
  ds_read_b128 a[96:99], v227 offset:6144
  ds_read_b128 a[224:227], v208 offset:0
  s_mov_b32 s43, 270336
  ds_read_b128 v[232:235], v225 offset:512
  v_mfma_f32_32x32x16_bf16 v[64:79], a[216:219], v[172:175], v[64:79]
  ds_read_b128 a[188:191], v203 offset:0
  v_mfma_f32_16x16x32_bf16 v[184:187], a[244:247], a[252:255], v[184:187]
  ds_read_b128 a[192:195], v200 offset:128
  s_add_u32 m0, s42, 0
  v_mfma_f32_32x32x16_bf16 v[80:95], a[220:223], v[172:175], v[80:95]
  ds_read_b128 a[100:103], v244 offset:6144
  ds_read_b128 a[228:231], v209 offset:0
  s_waitcnt lgkmcnt(8)
  v_mfma_f32_32x32x16_bf16 v[128:143], a[176:179], a[48:51], 0
  ds_read_b128 a[196:199], v201 offset:128
  v_mfma_f32_32x32x16_bf16 v[128:143], a[180:183], a[52:55], v[128:143]
  ds_read_b128 a[200:203], v202 offset:128
  buffer_load_dwordx4 v192, s[12:15], s43 offen offset:0 nt lds
  v_mul_f32 v0, v0, v217
  v_mul_f32 v1, v1, v217
  v_cvt_pk_bf16_f32 v0, v0, v1
  v_mul_f32 v2, v2, v217
  v_mul_f32 v3, v3, v217
  v_cvt_pk_bf16_f32 v1, v2, v3
  v_accvgpr_write_b32 a0, v0
  s_waitcnt lgkmcnt(6)
  v_add_f32 v232, v232, v233
  v_mfma_f32_32x32x16_bf16 v[128:143], a[184:187], a[56:59], v[128:143]
  ds_read_b128 a[104:107], v227 offset:6272
  ds_read_b128 a[232:235], v208 offset:128
  v_mul_f32 v4, v4, v217
  v_mul_f32 v5, v5, v217
  v_cvt_pk_bf16_f32 v2, v4, v5
  v_accvgpr_write_b32 a1, v1
  v_mul_f32 v6, v6, v217
  v_mul_f32 v7, v7, v217
  v_cvt_pk_bf16_f32 v3, v6, v7
  v_add_f32 v234, v234, v235
  v_mfma_f32_16x16x32_bf16 v[240:243], a[224:227], a[96:99], 0
  ds_read_b128 a[204:207], v203 offset:128
  buffer_load_dwordx4 v193, s[12:15], s43 offen offset:1024 nt lds
  v_accvgpr_write_b32 a2, v2
  v_mul_f32 v8, v8, v217
  v_mul_f32 v9, v9, v217
  v_cvt_pk_bf16_f32 v4, v8, v9
  v_accvgpr_write_b32 a3, v3
  v_mul_f32 v10, v10, v217
  v_mul_f32 v11, v11, v217
  v_add_f32 v232, v232, v234
  v_rcp_f32 v221, v232
  s_waitcnt lgkmcnt(7)
  v_mfma_f32_32x32x16_bf16 v[128:143], a[188:191], a[60:63], v[128:143]
  ds_read_b128 a[208:211], v200 offset:256
  v_cvt_pk_bf16_f32 v5, v10, v11
  v_accvgpr_write_b32 a4, v4
  v_mul_f32 v12, v12, v217
  v_mul_f32 v13, v13, v217
  v_cvt_pk_bf16_f32 v6, v12, v13
  v_accvgpr_write_b32 a5, v5
  v_mul_f32 v14, v14, v217
  v_mul_f32 v176, v176, v221
  v_mfma_f32_32x32x16_bf16 v[128:143], a[192:195], a[64:67], v[128:143]
  ds_read_b128 a[108:111], v244 offset:6272
  ds_read_b128 a[236:239], v209 offset:128
  v_mul_f32 v15, v15, v217
  v_cvt_pk_bf16_f32 v7, v14, v15
  v_accvgpr_write_b32 a6, v6
  v_mul_f32 v16, v16, v217
  v_mul_f32 v17, v17, v217
  v_cvt_pk_bf16_f32 v8, v16, v17
  v_accvgpr_write_b32 a7, v7
  v_mul_f32 v177, v177, v221
  v_mul_f32 v178, v178, v221
  s_waitcnt lgkmcnt(7)
  v_mfma_f32_16x16x32_bf16 v[240:243], a[228:231], a[100:103], v[240:243]
  ds_read_b128 a[212:215], v201 offset:256
  buffer_load_dwordx4 v194, s[12:15], s43 offen offset:2048 nt lds
  v_mul_f32 v18, v18, v217
  v_mul_f32 v19, v19, v217
  v_cvt_pk_bf16_f32 v9, v18, v19
  v_accvgpr_write_b32 a8, v8
  v_mul_f32 v20, v20, v217
  v_mul_f32 v21, v21, v217
  v_cvt_pk_bf16_f32 v10, v20, v21
  v_mul_f32 v179, v179, v221
  v_mfma_f32_32x32x16_bf16 v[128:143], a[196:199], a[68:71], v[128:143]
  ds_read_b128 a[216:219], v202 offset:256
  v_accvgpr_write_b32 a9, v9
  v_mul_f32 v22, v22, v217
  v_mul_f32 v23, v23, v217
  v_cvt_pk_bf16_f32 v11, v22, v23
  v_accvgpr_write_b32 a10, v10
  v_mul_f32 v24, v24, v217
  v_mul_f32 v180, v180, v221
  v_mul_f32 v181, v181, v221
  s_waitcnt lgkmcnt(6)
  v_mfma_f32_32x32x16_bf16 v[128:143], a[200:203], a[72:75], v[128:143]
  ds_read_b128 a[112:115], v227 offset:6400
  ds_read_b128 a[240:243], v208 offset:256
  s_add_u32 m0, s42, 3072
  v_mul_f32 v25, v25, v217
  v_cvt_pk_bf16_f32 v12, v24, v25
  v_accvgpr_write_b32 a11, v11
  v_mul_f32 v26, v26, v217
  v_mul_f32 v27, v27, v217
  v_cvt_pk_bf16_f32 v13, v26, v27
  v_accvgpr_write_b32 a12, v12
  v_mul_f32 v182, v182, v221
  v_mfma_f32_16x16x32_bf16 v[240:243], a[232:235], a[104:107], v[240:243]
  ds_read_b128 a[220:223], v203 offset:256
  v_mul_f32 v28, v28, v217
  v_mul_f32 v29, v29, v217
  v_cvt_pk_bf16_f32 v14, v28, v29
  v_accvgpr_write_b32 a13, v13
  v_mul_f32 v30, v30, v217
  v_mul_f32 v31, v31, v217
  v_cvt_pk_bf16_f32 v15, v30, v31
  v_mul_f32 v183, v183, v221
  s_waitcnt lgkmcnt(7)
  v_mfma_f32_32x32x16_bf16 v[128:143], a[204:207], a[76:79], v[128:143]
  ds_read_b128 a[176:179], v200 offset:12288
  v_accvgpr_write_b32 a14, v14
  v_mul_f32 v32, v32, v217
  v_mul_f32 v33, v33, v217
  v_cvt_pk_bf16_f32 v16, v32, v33
  v_accvgpr_write_b32 a15, v15
  v_mul_f32 v34, v34, v217
  v_mul_f32 v35, v35, v217
  v_mul_f32 v184, v184, v221
  v_mul_f32 v185, v185, v221
  v_mfma_f32_32x32x16_bf16 v[128:143], a[208:211], a[80:83], v[128:143]
  ds_read_b128 a[116:119], v244 offset:6400
  ds_read_b128 a[244:247], v209 offset:256
  buffer_load_dwordx4 v195, s[12:15], s43 offen offset:0 nt lds
  v_cvt_pk_bf16_f32 v17, v34, v35
  v_accvgpr_write_b32 a16, v16
  v_mul_f32 v36, v36, v217
  v_mul_f32 v37, v37, v217
  v_cvt_pk_bf16_f32 v18, v36, v37
  v_accvgpr_write_b32 a17, v17
  v_mul_f32 v38, v38, v217
  v_mul_f32 v186, v186, v221
  s_waitcnt lgkmcnt(7)
  v_mfma_f32_16x16x32_bf16 v[240:243], a[236:239], a[108:111], v[240:243]
  ds_read_b128 a[180:183], v201 offset:12288
  v_mul_f32 v39, v39, v217
  v_cvt_pk_bf16_f32 v19, v38, v39
  v_accvgpr_write_b32 a18, v18
  v_mul_f32 v40, v40, v217
  v_mul_f32 v41, v41, v217
  v_cvt_pk_bf16_f32 v20, v40, v41
  v_accvgpr_write_b32 a19, v19
  v_mul_f32 v187, v187, v221
  v_cvt_pk_bf16_f32 v176, v176, v177
  v_mfma_f32_32x32x16_bf16 v[128:143], a[212:215], a[84:87], v[128:143]
  ds_read_b128 a[184:187], v202 offset:12288
  buffer_load_dwordx4 v196, s[12:15], s43 offen offset:1024 nt lds
  v_mul_f32 v42, v42, v217
  v_mul_f32 v43, v43, v217
  v_cvt_pk_bf16_f32 v21, v42, v43
  v_accvgpr_write_b32 a20, v20
  v_mul_f32 v44, v44, v217
  v_mul_f32 v45, v45, v217
  v_cvt_pk_bf16_f32 v22, v44, v45
  v_cvt_pk_bf16_f32 v177, v178, v179
  s_waitcnt lgkmcnt(6)
  v_mfma_f32_32x32x16_bf16 v[128:143], a[216:219], a[88:91], v[128:143]
  ds_read_b128 a[188:191], v203 offset:12288
  v_accvgpr_write_b32 a21, v21
  v_mul_f32 v46, v46, v217
  v_mul_f32 v47, v47, v217
  v_cvt_pk_bf16_f32 v23, v46, v47
  v_accvgpr_write_b32 a22, v22
  v_mul_f32 v48, v48, v217
  ds_write_b64 v226, v[176:177] offset:0
  v_cvt_pk_bf16_f32 v180, v180, v181
  v_mfma_f32_16x16x32_bf16 v[240:243], a[240:243], a[112:115], v[240:243]
  ds_read_b128 a[192:195], v200 offset:12416
  v_mul_f32 v49, v49, v217
  v_cvt_pk_bf16_f32 v24, v48, v49
  v_accvgpr_write_b32 a23, v23
  v_mul_f32 v50, v50, v217
  v_mul_f32 v51, v51, v217
  v_cvt_pk_bf16_f32 v25, v50, v51
  v_accvgpr_write_b32 a24, v24
  v_cvt_pk_bf16_f32 v181, v182, v183
  s_waitcnt lgkmcnt(7)
  v_mfma_f32_32x32x16_bf16 v[128:143], a[220:223], a[92:95], v[128:143]
  ds_read_b128 a[196:199], v201 offset:12416
  buffer_load_dwordx4 v197, s[12:15], s43 offen offset:2048 nt lds
  v_mul_f32 v52, v52, v217
  v_mul_f32 v53, v53, v217
  v_cvt_pk_bf16_f32 v26, v52, v53
  v_accvgpr_write_b32 a25, v25
  v_mul_f32 v54, v54, v217
  v_mul_f32 v55, v55, v217
  v_cvt_pk_bf16_f32 v27, v54, v55
  ds_write_b64 v226, v[180:181] offset:128
  v_cvt_pk_bf16_f32 v184, v184, v185
  v_mfma_f32_32x32x16_bf16 v[144:159], a[176:179], a[48:51], 0
  ds_read_b128 a[200:203], v202 offset:12416
  v_accvgpr_write_b32 a26, v26
  v_mul_f32 v56, v56, v217
  v_mul_f32 v57, v57, v217
  v_cvt_pk_bf16_f32 v28, v56, v57
  v_accvgpr_write_b32 a27, v27
  v_mul_f32 v58, v58, v217
  v_mul_f32 v59, v59, v217
  v_cvt_pk_bf16_f32 v185, v186, v187
  s_waitcnt lgkmcnt(7)
  v_mfma_f32_16x16x32_bf16 v[240:243], a[244:247], a[116:119], v[240:243]
  ds_read_b128 a[204:207], v203 offset:12416
  v_cvt_pk_bf16_f32 v29, v58, v59
  v_accvgpr_write_b32 a28, v28
  v_mul_f32 v60, v60, v217
  v_mul_f32 v61, v61, v217
  v_cvt_pk_bf16_f32 v30, v60, v61
  v_accvgpr_write_b32 a29, v29
  v_mul_f32 v62, v62, v217
  ds_write_b64 v226, v[184:185] offset:256
  v_mfma_f32_32x32x16_bf16 v[144:159], a[180:183], a[52:55], v[144:159]
  ds_read_b128 a[208:211], v200 offset:12544
  v_mul_f32 v63, v63, v217
  v_cvt_pk_bf16_f32 v31, v62, v63
  v_accvgpr_write_b32 a30, v30
  v_mul_f32 v64, v64, v217
  v_mul_f32 v65, v65, v217
  v_cvt_pk_bf16_f32 v32, v64, v65
  v_accvgpr_write_b32 a31, v31
  s_waitcnt lgkmcnt(8)
  v_mfma_f32_32x32x16_bf16 v[144:159], a[184:187], a[56:59], v[144:159]
  ds_read_b128 a[212:215], v201 offset:12544
  v_max3_f32 v230, v240, v241, v242
  v_max_f32 v230, v230, v243
  v_mul_f32 v66, v66, v217
  v_mul_f32 v67, v67, v217
  v_cvt_pk_bf16_f32 v33, v66, v67
  v_accvgpr_write_b32 a32, v32
  v_mul_f32 v68, v68, v217
  v_mul_f32 v69, v69, v217
  v_cvt_pk_bf16_f32 v34, v68, v69
  v_mfma_f32_32x32x16_bf16 v[144:159], a[188:191], a[60:63], v[144:159]
  ds_read_b128 a[216:219], v202 offset:12544
  v_mov_b32 v231, v230
  s_nop 1
  v_permlane16_swap_b32 v231, v230
  v_accvgpr_write_b32 a33, v33
  v_mul_f32 v70, v70, v217
  v_mul_f32 v71, v71, v217
  v_cvt_pk_bf16_f32 v35, v70, v71
  v_accvgpr_write_b32 a34, v34
  v_mul_f32 v72, v72, v217
  s_waitcnt lgkmcnt(7)
  v_mfma_f32_32x32x16_bf16 v[144:159], a[192:195], a[64:67], v[144:159]
  ds_read_b128 a[220:223], v203 offset:12544
  v_max_f32 v230, v230, v231
  v_mov_b32 v231, v230
  v_mul_f32 v73, v73, v217
  v_cvt_pk_bf16_f32 v36, v72, v73
  v_accvgpr_write_b32 a35, v35
  v_mul_f32 v74, v74, v217
  v_mul_f32 v75, v75, v217
  v_cvt_pk_bf16_f32 v37, v74, v75
  v_accvgpr_write_b32 a36, v36
  v_mfma_f32_32x32x16_bf16 v[144:159], a[196:199], a[68:71], v[144:159]
  v_permlane32_swap_b32 v231, v230
  v_max_f32 v230, v230, v231
  v_mul_f32 v76, v76, v217
  v_mul_f32 v77, v77, v217
  v_cvt_pk_bf16_f32 v38, v76, v77
  v_accvgpr_write_b32 a37, v37
  v_mul_f32 v78, v78, v217
  v_mul_f32 v79, v79, v217
  v_cvt_pk_bf16_f32 v39, v78, v79
  s_waitcnt lgkmcnt(5)
  v_mfma_f32_32x32x16_bf16 v[144:159], a[200:203], a[72:75], v[144:159]
  ds_write_b32 v224, v230 offset:0
  v_accvgpr_write_b32 a38, v38
  v_mul_f32 v80, v80, v217
  v_mul_f32 v81, v81, v217
  v_cvt_pk_bf16_f32 v40, v80, v81
  v_accvgpr_write_b32 a39, v39
  v_mul_f32 v82, v82, v217
  v_mul_f32 v83, v83, v217
  v_mfma_f32_32x32x16_bf16 v[144:159], a[204:207], a[76:79], v[144:159]
  s_add_u32 s42, s39, s37
  s_add_u32 s39, s39, 24576
  s_cmp_eq_u32 s39, 147456
  s_cselect_b32 s39, 0, s39
  v_add_u32 v200, s39, v210
  v_xor_b32 v201, 32, v200
  v_xor_b32 v202, 64, v200
  v_xor_b32 v203, 96, v200
  v_add_u32 v208, s39, v211
  v_xor_b32 v209, 64, v208
  s_waitcnt vmcnt(24) lgkmcnt(0)
  s_barrier
  ds_read_b128 a[176:179], v200 offset:0
  ds_read_b128 a[180:183], v201 offset:0
  v_cvt_pk_bf16_f32 v41, v82, v83
  v_accvgpr_write_b32 a40, v40
  v_mul_f32 v84, v84, v217
  v_mul_f32 v85, v85, v217
  v_cvt_pk_bf16_f32 v42, v84, v85
  v_accvgpr_write_b32 a41, v41
  v_mul_f32 v86, v86, v217
  v_max3_f32 v218, v128, v129, v130
  v_max3_f32 v218, v218, v131, v132
  v_mfma_f32_32x32x16_bf16 v[144:159], a[208:211], a[80:83], v[144:159]
  ds_read_b128 a[184:187], v202 offset:0
  ds_read_b128 a[224:227], v208 offset:0
  v_mul_f32 v87, v87, v217
  v_cvt_pk_bf16_f32 v43, v86, v87
  v_accvgpr_write_b32 a42, v42
  v_mul_f32 v88, v88, v217
  v_mul_f32 v89, v89, v217
  v_cvt_pk_bf16_f32 v44, v88, v89
  v_accvgpr_write_b32 a43, v43
  v_max3_f32 v218, v218, v133, v134
  v_max3_f32 v218, v218, v135, v136
  s_mov_b32 s43, 245760
  ds_read_b128 v[232:235], v225 offset:0
  v_mfma_f32_32x32x16_bf16 v[144:159], a[212:215], a[84:87], v[144:159]
  ds_read_b128 a[188:191], v203 offset:0
  v_mul_f32 v90, v90, v217
  v_mul_f32 v91, v91, v217
  v_cvt_pk_bf16_f32 v45, v90, v91
  v_accvgpr_write_b32 a44, v44
  v_mul_f32 v92, v92, v217
  v_mul_f32 v93, v93, v217
  v_cvt_pk_bf16_f32 v46, v92, v93
  v_max3_f32 v218, v218, v137, v138
  v_max3_f32 v218, v218, v139, v140
  v_mfma_f32_32x32x16_bf16 v[144:159], a[216:219], a[88:91], v[144:159]
  ds_read_b128 a[192:195], v200 offset:128
  v_accvgpr_write_b32 a45, v45
  v_mul_f32 v94, v94, v217
  v_mul_f32 v95, v95, v217
  v_cvt_pk_bf16_f32 v47, v94, v95
  v_accvgpr_write_b32 a46, v46
  v_accvgpr_write_b32 a47, v47
  v_max3_f32 v218, v218, v141, v142
  v_max_f32 v218, v218, v143
  s_add_u32 m0, s42, 0
  v_mfma_f32_32x32x16_bf16 v[144:159], a[220:223], a[92:95], v[144:159]
  ds_read_b128 a[228:231], v209 offset:0
  s_waitcnt lgkmcnt(6)
  v_mfma_f32_32x32x16_bf16 v[96:111], a[176:179], a[48:51], 0
  ds_read_b128 a[196:199], v201 offset:128
  v_mfma_f32_32x32x16_bf16 v[96:111], a[180:183], a[52:55], v[96:111]
  ds_read_b128 a[200:203], v202 offset:128
  buffer_load_dwordx4 v192, s[16:19], s43 offen offset:0 nt lds
  s_nop 4
  v_max3_f32 v218, v218, v144, v145
  v_max3_f32 v218, v218, v146, v147
  v_max3_f32 v218, v218, v148, v149
  v_max3_f32 v218, v218, v150, v151
  v_max3_f32 v218, v218, v152, v153
  v_max3_f32 v218, v218, v154, v155
  s_waitcnt lgkmcnt(6)
  v_mfma_f32_32x32x16_bf16 v[96:111], a[184:187], a[56:59], v[96:111]
  ds_read_b128 a[232:235], v208 offset:128
  v_max3_f32 v218, v218, v156, v157
  v_max3_f32 v218, v218, v158, v159
  v_mov_b32 v228, v218
  s_nop 1
  v_permlane32_swap_b32 v228, v218
  v_max_f32 v218, v218, v228
  s_waitcnt lgkmcnt(6)
  v_max3_f32 v232, v232, v233, v234
  v_mfma_f32_16x16x32_bf16 v[188:191], a[224:227], a[96:99], 0
  ds_read_b128 a[204:207], v203 offset:128
  buffer_load_dwordx4 v193, s[16:19], s43 offen offset:1024 nt lds
  v_mov_b32 v214, v218
  v_mul_f32 v215, s47, v214
  v_mov_b32 v216, 0
  v_fma_f32 v128, v128, s47, -v215
  v_exp_f32 v128, v128
  v_max_f32 v232, v232, v235
  v_mul_f32 v219, s47, v232
  s_waitcnt lgkmcnt(5)
  v_mfma_f32_32x32x16_bf16 v[96:111], a[188:191], a[60:63], v[96:111]
  ds_read_b128 a[208:211], v200 offset:256
  v_fma_f32 v129, v129, s47, -v215
  v_exp_f32 v129, v129
  v_add_f32 v216, v216, v128
  v_fma_f32 v130, v130, s47, -v215
  v_exp_f32 v130, v130
  v_mov_b32 v220, 0
  v_mfma_f32_32x32x16_bf16 v[96:111], a[192:195], a[64:67], v[96:111]
  ds_read_b128 a[236:239], v209 offset:128
  v_add_f32 v216, v216, v129
  v_fma_f32 v131, v131, s47, -v215
  v_exp_f32 v131, v131
  v_add_f32 v216, v216, v130
  v_fma_f32 v132, v132, s47, -v215
  v_fma_f32 v240, v240, s47, -v219
  v_exp_f32 v240, v240
  s_waitcnt lgkmcnt(5)
  v_mfma_f32_16x16x32_bf16 v[188:191], a[228:231], a[100:103], v[188:191]
  ds_read_b128 a[212:215], v201 offset:256
  buffer_load_dwordx4 v194, s[16:19], s43 offen offset:2048 nt lds
  v_exp_f32 v132, v132
  v_add_f32 v216, v216, v131
  v_fma_f32 v133, v133, s47, -v215
  v_exp_f32 v133, v133
  v_add_f32 v216, v216, v132
  v_fma_f32 v241, v241, s47, -v219
  v_exp_f32 v241, v241
  v_mfma_f32_32x32x16_bf16 v[96:111], a[196:199], a[68:71], v[96:111]
  ds_read_b128 a[216:219], v202 offset:256
  v_fma_f32 v134, v134, s47, -v215
  v_exp_f32 v134, v134
  v_add_f32 v216, v216, v133
  v_fma_f32 v135, v135, s47, -v215
  v_exp_f32 v135, v135
  v_add_f32 v220, v220, v240
  s_waitcnt lgkmcnt(5)
  v_mfma_f32_32x32x16_bf16 v[96:111], a[200:203], a[72:75], v[96:111]
  ds_read_b128 a[240:243], v208 offset:256
  s_add_u32 m0, s42, 3072
  v_add_f32 v216, v216, v134
  v_fma_f32 v136, v136, s47, -v215
  v_exp_f32 v136, v136
  v_add_f32 v216, v216, v135
  v_fma_f32 v137, v137, s47, -v215
  v_fma_f32 v242, v242, s47, -v219
  v_exp_f32 v242, v242
  v_mfma_f32_16x16x32_bf16 v[188:191], a[232:235], a[104:107], v[188:191]
  ds_read_b128 a[220:223], v203 offset:256
  v_exp_f32 v137, v137
  v_add_f32 v216, v216, v136
  v_fma_f32 v138, v138, s47, -v215
  v_exp_f32 v138, v138
  v_add_f32 v216, v216, v137
  v_add_f32 v220, v220, v241
  s_waitcnt lgkmcnt(5)
  v_mfma_f32_32x32x16_bf16 v[96:111], a[204:207], a[76:79], v[96:111]
  ds_read_b128 a[176:179], v200 offset:12288
  v_fma_f32 v139, v139, s47, -v215
  v_exp_f32 v139, v139
  v_add_f32 v216, v216, v138
  v_fma_f32 v140, v140, s47, -v215
  v_exp_f32 v140, v140
  v_fma_f32 v243, v243, s47, -v219
  v_exp_f32 v243, v243
  v_mfma_f32_32x32x16_bf16 v[96:111], a[208:211], a[80:83], v[96:111]
  ds_read_b128 a[244:247], v209 offset:256
  buffer_load_dwordx4 v195, s[16:19], s43 offen offset:0 nt lds
  v_add_f32 v216, v216, v139
  v_fma_f32 v141, v141, s47, -v215
  v_exp_f32 v141, v141
  v_add_f32 v216, v216, v140
  v_fma_f32 v142, v142, s47, -v215
  v_add_f32 v220, v220, v242
  v_add_f32 v220, v220, v243
  s_waitcnt lgkmcnt(5)
  v_mfma_f32_16x16x32_bf16 v[188:191], a[236:239], a[108:111], v[188:191]
  ds_read_b128 a[180:183], v201 offset:12288
  v_exp_f32 v142, v142
  v_add_f32 v216, v216, v141
  v_fma_f32 v143, v143, s47, -v215
  v_exp_f32 v143, v143
  v_add_f32 v216, v216, v142
  v_cvt_pk_bf16_f32 v232, v240, v241
  v_mfma_f32_32x32x16_bf16 v[96:111], a[212:215], a[84:87], v[96:111]
  ds_read_b128 a[184:187], v202 offset:12288
  buffer_load_dwordx4 v196, s[16:19], s43 offen offset:1024 nt lds
  v_fma_f32 v144, v144, s47, -v215
  v_exp_f32 v144, v144
  v_add_f32 v216, v216, v143
  v_fma_f32 v145, v145, s47, -v215
  v_exp_f32 v145, v145
  v_cvt_pk_bf16_f32 v233, v242, v243
  ds_write_b64 v222, v[232:233] offset:6144
  s_waitcnt lgkmcnt(6)
  v_mfma_f32_32x32x16_bf16 v[96:111], a[216:219], a[88:91], v[96:111]
  ds_read_b128 a[188:191], v203 offset:12288
  v_add_f32 v216, v216, v144
  v_fma_f32 v146, v146, s47, -v215
  v_exp_f32 v146, v146
  v_add_f32 v216, v216, v145
  v_fma_f32 v147, v147, s47, -v215
  v_xor_b32 v222, 0x800, v222
  v_mfma_f32_16x16x32_bf16 v[188:191], a[240:243], a[112:115], v[188:191]
  ds_read_b128 a[192:195], v200 offset:12416
  v_exp_f32 v147, v147
  v_add_f32 v216, v216, v146
  v_fma_f32 v148, v148, s47, -v215
  v_exp_f32 v148, v148
  v_add_f32 v216, v216, v147
  s_waitcnt lgkmcnt(6)
  v_mfma_f32_32x32x16_bf16 v[96:111], a[220:223], a[92:95], v[96:111]
  ds_read_b128 a[196:199], v201 offset:12416
  buffer_load_dwordx4 v197, s[16:19], s43 offen offset:2048 nt lds
  v_fma_f32 v149, v149, s47, -v215
  v_exp_f32 v149, v149
  v_add_f32 v216, v216, v148
  v_fma_f32 v150, v150, s47, -v215
  v_exp_f32 v150, v150
  v_mfma_f32_32x32x16_bf16 v[112:127], a[176:179], a[48:51], 0
  ds_read_b128 a[200:203], v202 offset:12416
  v_add_f32 v216, v216, v149
  v_fma_f32 v151, v151, s47, -v215
  v_exp_f32 v151, v151
  v_add_f32 v216, v216, v150
  v_fma_f32 v152, v152, s47, -v215
  s_waitcnt lgkmcnt(6)
  v_mfma_f32_16x16x32_bf16 v[188:191], a[244:247], a[116:119], v[188:191]
  ds_read_b128 a[204:207], v203 offset:12416
  v_exp_f32 v152, v152
  v_add_f32 v216, v216, v151
  v_fma_f32 v153, v153, s47, -v215
  v_exp_f32 v153, v153
  v_add_f32 v216, v216, v152
  v_mfma_f32_32x32x16_bf16 v[112:127], a[180:183], a[52:55], v[112:127]
  ds_read_b128 a[208:211], v200 offset:12544
  v_fma_f32 v154, v154, s47, -v215
  v_exp_f32 v154, v154
  v_add_f32 v216, v216, v153
  v_fma_f32 v155, v155, s47, -v215
  v_exp_f32 v155, v155
  s_waitcnt lgkmcnt(5)
  v_mfma_f32_32x32x16_bf16 v[112:127], a[184:187], a[56:59], v[112:127]
  ds_read_b128 a[212:215], v201 offset:12544
  v_max3_f32 v230, v188, v189, v190
  v_max_f32 v230, v230, v191
  v_add_f32 v216, v216, v154
  v_fma_f32 v156, v156, s47, -v215
  v_exp_f32 v156, v156
  v_add_f32 v216, v216, v155
  v_fma_f32 v157, v157, s47, -v215
  v_mfma_f32_32x32x16_bf16 v[112:127], a[188:191], a[60:63], v[112:127]
  ds_read_b128 a[216:219], v202 offset:12544
  v_mov_b32 v231, v230
  s_nop 1
  v_permlane16_swap_b32 v231, v230
  v_exp_f32 v157, v157
  v_add_f32 v216, v216, v156
  v_fma_f32 v158, v158, s47, -v215
  v_exp_f32 v158, v158
  v_add_f32 v216, v216, v157
  s_waitcnt lgkmcnt(5)
  v_mfma_f32_32x32x16_bf16 v[112:127], a[192:195], a[64:67], v[112:127]
  ds_read_b128 a[220:223], v203 offset:12544
  v_max_f32 v230, v230, v231
  v_mov_b32 v231, v230
  v_fma_f32 v159, v159, s47, -v215
  v_exp_f32 v159, v159
  v_add_f32 v216, v216, v158
  v_add_f32 v216, v216, v159
  v_cvt_pk_bf16_f32 v160, v128, v129
  v_mfma_f32_32x32x16_bf16 v[112:127], a[196:199], a[68:71], v[112:127]
  v_permlane32_swap_b32 v231, v230
  v_max_f32 v230, v230, v231
  v_cvt_pk_bf16_f32 v161, v130, v131
  v_cvt_pk_bf16_f32 v162, v132, v133
  v_cvt_pk_bf16_f32 v163, v134, v135
  v_cvt_pk_bf16_f32 v164, v136, v137
  v_cvt_pk_bf16_f32 v165, v138, v139
  s_waitcnt lgkmcnt(4)
  v_mfma_f32_32x32x16_bf16 v[112:127], a[200:203], a[72:75], v[112:127]
  ds_write_b32 v224, v230 offset:256
  v_cvt_pk_bf16_f32 v166, v140, v141
  v_cvt_pk_bf16_f32 v167, v142, v143
  v_cvt_pk_bf16_f32 v168, v144, v145
  v_cvt_pk_bf16_f32 v169, v146, v147
  v_cvt_pk_bf16_f32 v170, v148, v149
  v_mfma_f32_32x32x16_bf16 v[112:127], a[204:207], a[76:79], v[112:127]
  s_add_u32 s42, s39, s37
  s_add_u32 s39, s39, 24576
  s_cmp_eq_u32 s39, 147456
  s_cselect_b32 s39, 0, s39
  v_add_u32 v204, s39, v212
  v_xor_b32 v205, 32, v204
  v_xor_b32 v206, 64, v204
  v_xor_b32 v207, 96, v204
  v_add_u32 v198, s39, v213
  v_xor_b32 v199, 48, v198
  v_xor_b32 v244, 64, v223
  s_waitcnt vmcnt(24) lgkmcnt(0)
  s_barrier
  ds_read_b64_tr_b16 a[176:177], v204 offset:0
  ds_read_b64_tr_b16 a[178:179], v205 offset:3072
  ds_read_b64_tr_b16 a[180:181], v206 offset:0
  ds_read_b64_tr_b16 a[182:183], v207 offset:3072
  v_cvt_pk_bf16_f32 v171, v150, v151
  v_cvt_pk_bf16_f32 v172, v152, v153
  v_cvt_pk_bf16_f32 v173, v154, v155
  v_cvt_pk_bf16_f32 v174, v156, v157
  v_cvt_pk_bf16_f32 v175, v158, v159
  v_mfma_f32_32x32x16_bf16 v[112:127], a[208:211], a[80:83], v[112:127]
  ds_read_b64_tr_b16 a[184:185], v204 offset:128
  ds_read_b64_tr_b16 a[186:187], v205 offset:3200
  ds_read_b64_tr_b16 a[188:189], v206 offset:128
  ds_read_b64_tr_b16 a[190:191], v207 offset:3200
  v_max3_f32 v218, v96, v97, v98
  v_max3_f32 v218, v218, v99, v100
  v_max3_f32 v218, v218, v101, v102
  ds_read_b128 v[232:235], v225 offset:256
  s_mov_b32 s44, 294912
  v_mfma_f32_32x32x16_bf16 v[112:127], a[212:215], a[84:87], v[112:127]
  ds_read_b128 a[248:251], v223 offset:6144
  ds_read_b128 a[252:255], v244 offset:6144
  v_xor_b32 v223, 0x800, v223
  ds_read_b64_tr_b16 a[224:225], v198 offset:0
  ds_read_b64_tr_b16 a[226:227], v199 offset:1536
  v_max3_f32 v218, v218, v103, v104
  v_max3_f32 v218, v218, v105, v106
  v_max3_f32 v218, v218, v107, v108
  v_mfma_f32_32x32x16_bf16 v[112:127], a[216:219], a[88:91], v[112:127]
  ds_read_b64_tr_b16 a[192:193], v204 offset:256
  ds_read_b64_tr_b16 a[194:195], v205 offset:3328
  v_max3_f32 v218, v218, v109, v110
  v_max_f32 v218, v218, v111
  s_add_u32 m0, s42, 0
  v_mfma_f32_32x32x16_bf16 v[112:127], a[220:223], a[92:95], v[112:127]
  ds_read_b64_tr_b16 a[196:197], v206 offset:256
  ds_read_b64_tr_b16 a[198:199], v207 offset:3328
  s_waitcnt lgkmcnt(13)
  v_mfma_f32_32x32x16_bf16 v[0:15], a[176:179], v[160:163], 0
  ds_read_b64_tr_b16 a[200:201], v204 offset:6144
  ds_read_b64_tr_b16 a[202:203], v205 offset:9216
  v_mfma_f32_32x32x16_bf16 v[16:31], a[180:183], v[160:163], 0
  ds_read_b64_tr_b16 a[204:205], v206 offset:6144
  ds_read_b64_tr_b16 a[206:207], v207 offset:9216
  s_nop 2
  v_max3_f32 v218, v218, v112, v113
  v_max3_f32 v218, v218, v114, v115
  v_max3_f32 v218, v218, v116, v117
  buffer_load_dwordx4 v192, s[12:15], s44 offen offset:0 nt lds
  s_waitcnt lgkmcnt(13)
  v_mfma_f32_32x32x16_bf16 v[32:47], a[184:187], v[160:163], 0
  ds_read_b64_tr_b16 a[228:229], v198 offset:128
  ds_read_b64_tr_b16 a[230:231], v199 offset:1664
  v_max3_f32 v218, v218, v118, v119
  v_max3_f32 v218, v218, v120, v121
  v_max3_f32 v218, v218, v122, v123
  v_mfma_f32_32x32x16_bf16 v[48:63], a[188:191], v[160:163], 0
  ds_read_b64_tr_b16 a[208:209], v204 offset:6272
  ds_read_b64_tr_b16 a[210:211], v205 offset:9344
  v_max3_f32 v218, v218, v124, v125
  v_max3_f32 v218, v218, v126, v127
  v_mov_b32 v228, v218
  s_waitcnt lgkmcnt(15)
  v_max3_f32 v232, v232, v233, v234
  buffer_load_dwordx4 v193, s[12:15], s44 offen offset:1024 nt lds
  s_waitcnt lgkmcnt(10)
  v_mfma_f32_16x16x32_bf16 v[176:179], a[224:227], a[248:251], 0
  ds_read_b64_tr_b16 a[212:213], v206 offset:6272
  ds_read_b64_tr_b16 a[214:215], v207 offset:9344
  v_permlane32_swap_b32 v228, v218
  v_max_f32 v218, v218, v228
  v_add_f32 v228, s48, v214
  v_max_f32 v232, v232, v235
  v_mfma_f32_32x32x16_bf16 v[64:79], a[192:195], v[160:163], 0
  ds_read_b64_tr_b16 a[216:217], v204 offset:6400
  ds_read_b64_tr_b16 a[218:219], v205 offset:9472
  v_cmp_gt_f32 s[50:51], v218, v228
  v_mov_b32 v229, v215
  s_nop 0
  v_cndmask_b32 v214, v214, v218, s[50:51]
  v_mul_f32 v232, s47, v232
  s_waitcnt lgkmcnt(10)
  v_mfma_f32_32x32x16_bf16 v[80:95], a[196:199], v[160:163], 0
  ds_read_b64_tr_b16 a[220:221], v206 offset:6400
  ds_read_b64_tr_b16 a[222:223], v207 offset:9472
  v_mul_f32 v215, s47, v214
  v_sub_f32 v217, v229, v215
  v_exp_f32 v217, v217
  v_max_f32 v232, v232, v219
  buffer_load_dwordx4 v194, s[12:15], s44 offen offset:2048 nt lds
  v_mfma_f32_32x32x16_bf16 v[0:15], a[200:203], v[164:167], v[0:15]
  ds_read_b64_tr_b16 a[232:233], v198 offset:256
  ds_read_b64_tr_b16 a[234:235], v199 offset:1792
  v_mul_f32 v216, v216, v217
  v_fma_f32 v96, v96, s47, -v215
  v_sub_f32 v221, v219, v232
  v_exp_f32 v221, v221
  s_waitcnt lgkmcnt(10)
  v_mfma_f32_32x32x16_bf16 v[16:31], a[204:207], v[164:167], v[16:31]
  ds_read_b64_tr_b16 a[176:177], v204 offset:12288
  ds_read_b64_tr_b16 a[178:179], v205 offset:15360
  v_exp_f32 v96, v96
  v_fma_f32 v97, v97, s47, -v215
  v_exp_f32 v97, v97
  v_mov_b32 v219, v232
  s_add_u32 m0, s42, 3072
  v_mfma_f32_16x16x32_bf16 v[180:183], a[228:231], a[248:251], 0
  ds_read_b64_tr_b16 a[180:181], v206 offset:12288
  ds_read_b64_tr_b16 a[182:183], v207 offset:15360
  v_add_f32 v216, v216, v96
  v_fma_f32 v98, v98, s47, -v215
  v_exp_f32 v98, v98
  v_mul_f32 v220, v220, v221
  s_waitcnt lgkmcnt(10)
  v_mfma_f32_32x32x16_bf16 v[32:47], a[208:211], v[164:167], v[32:47]
  ds_read_b64_tr_b16 a[184:185], v204 offset:12416
  ds_read_b64_tr_b16 a[186:187], v205 offset:15488
  v_add_f32 v216, v216, v97
  v_fma_f32 v99, v99, s47, -v215
  v_exp_f32 v99, v99
  v_fma_f32 v188, v188, s47, -v219
  v_mfma_f32_32x32x16_bf16 v[48:63], a[212:215], v[164:167], v[48:63]
  ds_read_b64_tr_b16 a[188:189], v206 offset:12416
  ds_read_b64_tr_b16 a[190:191], v207 offset:15488
  v_add_f32 v216, v216, v98
  v_fma_f32 v100, v100, s47, -v215
  v_exp_f32 v100, v100
  v_exp_f32 v188, v188
  v_fma_f32 v189, v189, s47, -v219
  buffer_load_dwordx4 v195, s[12:15], s44 offen offset:0 nt lds
  s_waitcnt lgkmcnt(10)
  v_mfma_f32_32x32x16_bf16 v[64:79], a[216:219], v[164:167], v[64:79]
  ds_read_b64_tr_b16 a[236:237], v198 offset:12288
  ds_read_b64_tr_b16 a[238:239], v199 offset:13824
  v_add_f32 v216, v216, v99
  v_fma_f32 v101, v101, s47, -v215
  v_exp_f32 v101, v101
  v_exp_f32 v189, v189
  v_mfma_f32_32x32x16_bf16 v[80:95], a[220:223], v[164:167], v[80:95]
  ds_read_b64_tr_b16 a[192:193], v204 offset:12544
  ds_read_b64_tr_b16 a[194:195], v205 offset:15616
  v_add_f32 v216, v216, v100
  v_add_f32 v216, v216, v101
  v_add_f32 v220, v220, v188
  buffer_load_dwordx4 v196, s[12:15], s44 offen offset:1024 nt lds
  s_waitcnt lgkmcnt(10)
  v_mfma_f32_16x16x32_bf16 v[184:187], a[232:235], a[248:251], 0
  ds_read_b64_tr_b16 a[196:197], v206 offset:12544
  ds_read_b64_tr_b16 a[198:199], v207 offset:15616
  v_fma_f32 v102, v102, s47, -v215
  v_exp_f32 v102, v102
  v_fma_f32 v103, v103, s47, -v215
  v_fma_f32 v190, v190, s47, -v219
  v_mfma_f32_32x32x16_bf16 v[0:15], a[176:179], v[168:171], v[0:15]
  ds_read_b64_tr_b16 a[200:201], v204 offset:18432
  ds_read_b64_tr_b16 a[202:203], v205 offset:21504
  v_exp_f32 v103, v103
  v_add_f32 v216, v216, v102
  v_fma_f32 v104, v104, s47, -v215
  v_exp_f32 v190, v190
  v_add_f32 v220, v220, v189
  s_mov_b32 s28, s16
  s_mov_b32 s29, s17
  s_waitcnt lgkmcnt(10)
  v_mfma_f32_32x32x16_bf16 v[16:31], a[180:183], v[168:171], v[16:31]
  ds_read_b64_tr_b16 a[204:205], v206 offset:18432
  ds_read_b64_tr_b16 a[206:207], v207 offset:21504
  v_exp_f32 v104, v104
  v_add_f32 v216, v216, v103
  v_fma_f32 v191, v191, s47, -v219
  buffer_load_dwordx4 v197, s[12:15], s44 offen offset:2048 nt lds
  s_mov_b32 s30, s18
  s_mov_b32 s32, s12
  v_mfma_f32_32x32x16_bf16 v[32:47], a[184:187], v[168:171], v[32:47]
  ds_read_b64_tr_b16 a[240:241], v198 offset:12416
  ds_read_b64_tr_b16 a[242:243], v199 offset:13952
  v_fma_f32 v105, v105, s47, -v215
  v_exp_f32 v105, v105
  v_add_f32 v216, v216, v104
  v_exp_f32 v191, v191
  s_mov_b32 s33, s13
  s_mov_b32 s34, s14
  s_waitcnt lgkmcnt(10)
  v_mfma_f32_32x32x16_bf16 v[48:63], a[188:191], v[168:171], v[48:63]
  ds_read_b64_tr_b16 a[208:209], v204 offset:18560
  ds_read_b64_tr_b16 a[210:211], v205 offset:21632
  v_fma_f32 v106, v106, s47, -v215
  v_exp_f32 v106, v106
  v_add_f32 v220, v220, v190
  s_mov_b32 s45, 1
  v_mfma_f32_16x16x32_bf16 v[176:179], a[236:239], a[252:255], v[176:179]
  ds_read_b64_tr_b16 a[212:213], v206 offset:18560
  ds_read_b64_tr_b16 a[214:215], v207 offset:21632
  v_add_f32 v216, v216, v105
  v_fma_f32 v107, v107, s47, -v215
  v_exp_f32 v107, v107
  v_add_f32 v220, v220, v191
  v_cvt_pk_bf16_f32 v232, v188, v189
  s_waitcnt lgkmcnt(10)
  v_mfma_f32_32x32x16_bf16 v[64:79], a[192:195], v[168:171], v[64:79]
  ds_read_b64_tr_b16 a[216:217], v204 offset:18688
  ds_read_b64_tr_b16 a[218:219], v205 offset:21760
  v_add_f32 v216, v216, v106
  v_fma_f32 v108, v108, s47, -v215
  v_cvt_pk_bf16_f32 v233, v190, v191
  v_mfma_f32_32x32x16_bf16 v[80:95], a[196:199], v[168:171], v[80:95]
LI1:
  ds_read_b64_tr_b16 a[220:221], v206 offset:18688
  ds_read_b64_tr_b16 a[222:223], v207 offset:21760
  v_exp_f32 v108, v108
  v_add_f32 v216, v216, v107
  v_fma_f32 v109, v109, s47, -v215
  ds_write_b64 v222, v[232:233] offset:6144
  s_waitcnt lgkmcnt(11)
  v_mfma_f32_32x32x16_bf16 v[0:15], a[200:203], v[172:175], v[0:15]
  ds_read_b64_tr_b16 a[244:245], v198 offset:12544
  ds_read_b64_tr_b16 a[246:247], v199 offset:14080
  v_exp_f32 v109, v109
  v_add_f32 v216, v216, v108
  v_xor_b32 v222, 0x800, v222
  v_mfma_f32_32x32x16_bf16 v[16:31], a[204:207], v[172:175], v[16:31]
  v_fma_f32 v110, v110, s47, -v215
  v_exp_f32 v110, v110
  v_add_f32 v216, v216, v109
  s_waitcnt lgkmcnt(9)
  v_mfma_f32_16x16x32_bf16 v[180:183], a[240:243], a[252:255], v[180:183]
  v_fma_f32 v111, v111, s47, -v215
  v_exp_f32 v111, v111
  v_mfma_f32_32x32x16_bf16 v[32:47], a[208:211], v[172:175], v[32:47]
  s_add_u32 s42, s39, s37
  s_add_u32 s39, s39, 24576
  s_cmp_eq_u32 s39, 147456
  s_cselect_b32 s39, 0, s39
  v_add_u32 v200, s39, v210
  v_xor_b32 v201, 32, v200
  v_xor_b32 v202, 64, v200
  v_xor_b32 v203, 96, v200
  v_add_u32 v208, s39, v211
  v_xor_b32 v209, 64, v208
  s_waitcnt vmcnt(24) lgkmcnt(0)
  s_barrier
  ds_read_b128 a[176:179], v200 offset:0
  ds_read_b128 a[180:183], v201 offset:0
  v_add_f32 v216, v216, v110
  v_add_f32 v216, v216, v111
  v_cvt_pk_bf16_f32 v160, v96, v97
  s_add_u32 s43, s43, 24576
  s_add_u32 s44, s44, 24576
  s_cmp_eq_u32 s45, 4
  s_cbranch_scc1 XG41
YG41:
  v_mfma_f32_32x32x16_bf16 v[48:63], a[212:215], v[172:175], v[48:63]
  ds_read_b128 a[184:187], v202 offset:0
  ds_read_b128 a[224:227], v208 offset:0
  v_cvt_pk_bf16_f32 v161, v98, v99
  v_cvt_pk_bf16_f32 v162, v100, v101
  s_cmp_eq_u32 s45, 5
  s_cbranch_scc1 XG51
YG51:
  s_cmp_eq_u32 s45, 6
  s_cbranch_scc1 XG61
YG61:
  v_mfma_f32_32x32x16_bf16 v[64:79], a[216:219], v[172:175], v[64:79]
  ds_read_b128 a[188:191], v203 offset:0
  v_cvt_pk_bf16_f32 v163, v102, v103
  v_cvt_pk_bf16_f32 v164, v104, v105
  v_cvt_pk_bf16_f32 v165, v106, v107
  v_mfma_f32_32x32x16_bf16 v[80:95], a[220:223], v[172:175], v[80:95]
  ds_read_b128 a[192:195], v200 offset:128
  v_cvt_pk_bf16_f32 v166, v108, v109
  v_cvt_pk_bf16_f32 v167, v110, v111
  s_add_u32 m0, s42, 0
  v_mfma_f32_16x16x32_bf16 v[184:187], a[244:247], a[252:255], v[184:187]
  ds_read_b128 a[228:231], v209 offset:0
  v_fma_f32 v112, v112, s47, -v215
  v_exp_f32 v112, v112
  v_fma_f32 v113, v113, s47, -v215
  v_exp_f32 v113, v113
  s_waitcnt lgkmcnt(5)
  v_mfma_f32_32x32x16_bf16 v[96:111], a[176:179], a[48:51], 0
  ds_read_b128 a[196:199], v201 offset:128
  buffer_load_dwordx4 v192, s[28:31], s43 offen offset:0 nt lds
  v_add_f32 v216, v216, v112
  v_fma_f32 v114, v114, s47, -v215
  v_exp_f32 v114, v114
  v_add_f32 v216, v216, v113
  v_mfma_f32_32x32x16_bf16 v[96:111], a[180:183], a[52:55], v[96:111]
  ds_read_b128 a[200:203], v202 offset:128
  v_fma_f32 v115, v115, s47, -v215
  v_exp_f32 v115, v115
  v_add_f32 v216, v216, v114
  v_fma_f32 v116, v116, s47, -v215
  s_waitcnt lgkmcnt(5)
  v_mfma_f32_32x32x16_bf16 v[96:111], a[184:187], a[56:59], v[96:111]
  ds_read_b128 a[232:235], v208 offset:128
  v_exp_f32 v116, v116
  v_add_f32 v216, v216, v115
  v_fma_f32 v117, v117, s47, -v215
  v_mfma_f32_16x16x32_bf16 v[188:191], a[224:227], a[96:99], 0
  ds_read_b128 a[204:207], v203 offset:128
  buffer_load_dwordx4 v193, s[28:31], s43 offen offset:1024 nt lds
  v_exp_f32 v117, v117
  v_add_f32 v216, v216, v116
  v_fma_f32 v118, v118, s47, -v215
  v_exp_f32 v118, v118
  s_waitcnt lgkmcnt(5)
  v_mfma_f32_32x32x16_bf16 v[96:111], a[188:191], a[60:63], v[96:111]
  ds_read_b128 a[208:211], v200 offset:256
  v_add_f32 v216, v216, v117
  v_fma_f32 v119, v119, s47, -v215
  v_exp_f32 v119, v119
  v_add_f32 v216, v216, v118
  v_mfma_f32_32x32x16_bf16 v[96:111], a[192:195], a[64:67], v[96:111]
  ds_read_b128 a[236:239], v209 offset:128
  buffer_load_dwordx4 v194, s[28:31], s43 offen offset:2048 nt lds
  v_fma_f32 v120, v120, s47, -v215
  v_exp_f32 v120, v120
  v_add_f32 v216, v216, v119
  v_fma_f32 v121, v121, s47, -v215
  s_waitcnt lgkmcnt(5)
  v_mfma_f32_16x16x32_bf16 v[188:191], a[228:231], a[100:103], v[188:191]
  ds_read_b128 a[212:215], v201 offset:256
  v_exp_f32 v121, v121
  v_add_f32 v216, v216, v120
  v_fma_f32 v122, v122, s47, -v215
  v_mfma_f32_32x32x16_bf16 v[96:111], a[196:199], a[68:71], v[96:111]
  ds_read_b128 a[216:219], v202 offset:256
  v_exp_f32 v122, v122
  v_add_f32 v216, v216, v121
  v_fma_f32 v123, v123, s47, -v215
  v_exp_f32 v123, v123
  s_waitcnt lgkmcnt(5)
  v_mfma_f32_32x32x16_bf16 v[96:111], a[200:203], a[72:75], v[96:111]
  ds_read_b128 a[240:243], v208 offset:256
  s_add_u32 m0, s42, 3072
  v_add_f32 v216, v216, v122
  v_fma_f32 v124, v124, s47, -v215
  v_exp_f32 v124, v124
  v_add_f32 v216, v216, v123
  v_mfma_f32_16x16x32_bf16 v[188:191], a[232:235], a[104:107], v[188:191]
  ds_read_b128 a[220:223], v203 offset:256
  v_fma_f32 v125, v125, s47, -v215
  v_exp_f32 v125, v125
  v_add_f32 v216, v216, v124
  v_fma_f32 v126, v126, s47, -v215
  s_waitcnt lgkmcnt(5)
  v_mfma_f32_32x32x16_bf16 v[96:111], a[204:207], a[76:79], v[96:111]
  ds_read_b128 a[176:179], v200 offset:12288
  v_exp_f32 v126, v126
  v_add_f32 v216, v216, v125
  v_fma_f32 v127, v127, s47, -v215
  v_mfma_f32_32x32x16_bf16 v[96:111], a[208:211], a[80:83], v[96:111]
  ds_read_b128 a[244:247], v209 offset:256
  buffer_load_dwordx4 v195, s[28:31], s43 offen offset:0 nt lds
  v_exp_f32 v127, v127
  v_add_f32 v216, v216, v126
  v_add_f32 v216, v216, v127
  v_cvt_pk_bf16_f32 v168, v112, v113
  s_waitcnt lgkmcnt(5)
  v_mfma_f32_16x16x32_bf16 v[188:191], a[236:239], a[108:111], v[188:191]
  ds_read_b128 a[180:183], v201 offset:12288
  v_cvt_pk_bf16_f32 v169, v114, v115
  v_cvt_pk_bf16_f32 v170, v116, v117
  v_cvt_pk_bf16_f32 v171, v118, v119
  v_cvt_pk_bf16_f32 v172, v120, v121
  v_mfma_f32_32x32x16_bf16 v[96:111], a[212:215], a[84:87], v[96:111]
  ds_read_b128 a[184:187], v202 offset:12288
  buffer_load_dwordx4 v196, s[28:31], s43 offen offset:1024 nt lds
  v_cvt_pk_bf16_f32 v173, v122, v123
  v_cvt_pk_bf16_f32 v174, v124, v125
  v_cvt_pk_bf16_f32 v175, v126, v127
  s_waitcnt lgkmcnt(5)
  v_mfma_f32_32x32x16_bf16 v[96:111], a[216:219], a[88:91], v[96:111]
  ds_read_b128 a[188:191], v203 offset:12288
  v_mul_f32 v176, v176, v221
  v_mul_f32 v177, v177, v221
  v_mfma_f32_16x16x32_bf16 v[188:191], a[240:243], a[112:115], v[188:191]
  ds_read_b128 a[192:195], v200 offset:12416
  v_mul_f32 v178, v178, v221
  v_mul_f32 v179, v179, v221
  s_waitcnt lgkmcnt(5)
  v_mfma_f32_32x32x16_bf16 v[96:111], a[220:223], a[92:95], v[96:111]
  ds_read_b128 a[196:199], v201 offset:12416
  buffer_load_dwordx4 v197, s[28:31], s43 offen offset:2048 nt lds
  v_mul_f32 v180, v180, v221
  v_mul_f32 v181, v181, v221
  v_mfma_f32_32x32x16_bf16 v[112:127], a[176:179], a[48:51], 0
  ds_read_b128 a[200:203], v202 offset:12416
  v_mul_f32 v182, v182, v221
  v_mul_f32 v183, v183, v221
  s_waitcnt lgkmcnt(5)
  v_mfma_f32_16x16x32_bf16 v[188:191], a[244:247], a[116:119], v[188:191]
  ds_read_b128 a[204:207], v203 offset:12416
  v_mul_f32 v184, v184, v221
  v_mul_f32 v185, v185, v221
  v_mfma_f32_32x32x16_bf16 v[112:127], a[180:183], a[52:55], v[112:127]
  ds_read_b128 a[208:211], v200 offset:12544
  v_mul_f32 v186, v186, v221
  v_mul_f32 v187, v187, v221
  s_waitcnt lgkmcnt(5)
  v_mfma_f32_32x32x16_bf16 v[112:127], a[184:187], a[56:59], v[112:127]
  ds_read_b128 a[212:215], v201 offset:12544
  v_max3_f32 v230, v188, v189, v190
  v_max_f32 v230, v230, v191
  v_mfma_f32_32x32x16_bf16 v[112:127], a[188:191], a[60:63], v[112:127]
  ds_read_b128 a[216:219], v202 offset:12544
  v_mov_b32 v231, v230
  s_nop 1
  v_permlane16_swap_b32 v231, v230
  s_waitcnt lgkmcnt(5)
  v_mfma_f32_32x32x16_bf16 v[112:127], a[192:195], a[64:67], v[112:127]
  ds_read_b128 a[220:223], v203 offset:12544
  v_max_f32 v230, v230, v231
  v_mov_b32 v231, v230
  v_mfma_f32_32x32x16_bf16 v[112:127], a[196:199], a[68:71], v[112:127]
  s_nop 0
  v_permlane32_swap_b32 v231, v230
  v_max_f32 v230, v230, v231
  v_max3_f32 v218, v96, v97, v98
  v_max3_f32 v218, v218, v99, v100
  s_waitcnt lgkmcnt(4)
  v_mfma_f32_32x32x16_bf16 v[112:127], a[200:203], a[72:75], v[112:127]
  ds_write_b32 v224, v230 offset:256
  v_max3_f32 v218, v218, v101, v102
  v_mfma_f32_32x32x16_bf16 v[112:127], a[204:207], a[76:79], v[112:127]
  s_add_u32 s42, s39, s37
  s_add_u32 s39, s39, 24576
  s_cmp_eq_u32 s39, 147456
  s_cselect_b32 s39, 0, s39
  v_add_u32 v204, s39, v212
  v_xor_b32 v205, 32, v204
  v_xor_b32 v206, 64, v204
  v_xor_b32 v207, 96, v204
  v_add_u32 v198, s39, v213
  v_xor_b32 v199, 48, v198
  v_xor_b32 v244, 64, v223
  s_waitcnt vmcnt(24) lgkmcnt(0)
  s_barrier
  ds_read_b64_tr_b16 a[176:177], v204 offset:0
  ds_read_b64_tr_b16 a[178:179], v205 offset:3072
  ds_read_b64_tr_b16 a[180:181], v206 offset:0
  ds_read_b64_tr_b16 a[182:183], v207 offset:3072
  v_max3_f32 v218, v218, v103, v104
  v_mfma_f32_32x32x16_bf16 v[112:127], a[208:211], a[80:83], v[112:127]
  ds_read_b64_tr_b16 a[184:185], v204 offset:128
  ds_read_b64_tr_b16 a[186:187], v205 offset:3200
  ds_read_b64_tr_b16 a[188:189], v206 offset:128
  ds_read_b64_tr_b16 a[190:191], v207 offset:3200
  v_max3_f32 v218, v218, v105, v106
  v_max3_f32 v218, v218, v107, v108
  ds_read_b128 v[232:235], v225 offset:256
  s_add_u32 m0, s42, 0
  v_mfma_f32_32x32x16_bf16 v[112:127], a[212:215], a[84:87], v[112:127]
  ds_read_b128 a[248:251], v223 offset:6144
  ds_read_b128 a[252:255], v244 offset:6144
  v_xor_b32 v223, 0x800, v223
  ds_read_b64_tr_b16 a[224:225], v198 offset:0
  ds_read_b64_tr_b16 a[226:227], v199 offset:1536
  v_max3_f32 v218, v218, v109, v110
  v_mfma_f32_32x32x16_bf16 v[112:127], a[216:219], a[88:91], v[112:127]
  ds_read_b64_tr_b16 a[192:193], v204 offset:256
  ds_read_b64_tr_b16 a[194:195], v205 offset:3328
  v_max_f32 v218, v218, v111
  buffer_load_dwordx4 v192, s[32:35], s44 offen offset:0 nt lds
  v_mfma_f32_32x32x16_bf16 v[112:127], a[220:223], a[92:95], v[112:127]
  ds_read_b64_tr_b16 a[196:197], v206 offset:256
  ds_read_b64_tr_b16 a[198:199], v207 offset:3328
  s_cmp_lg_u64 s[50:51], 0
  s_cbranch_scc1 RARE1
RET1:
  s_waitcnt lgkmcnt(13)
  v_mfma_f32_32x32x16_bf16 v[0:15], a[176:179], v[160:163], v[0:15]
  ds_read_b64_tr_b16 a[200:201], v204 offset:6144
  ds_read_b64_tr_b16 a[202:203], v205 offset:9216
  v_mfma_f32_32x32x16_bf16 v[16:31], a[180:183], v[160:163], v[16:31]
  ds_read_b64_tr_b16 a[204:205], v206 offset:6144
  ds_read_b64_tr_b16 a[206:207], v207 offset:9216
  s_nop 0
  v_max3_f32 v218, v218, v112, v113
  v_max3_f32 v218, v218, v114, v115
  v_max3_f32 v218, v218, v116, v117
  buffer_load_dwordx4 v193, s[32:35], s44 offen offset:1024 nt lds
  s_waitcnt lgkmcnt(13)
  v_mfma_f32_32x32x16_bf16 v[32:47], a[184:187], v[160:163], v[32:47]
  ds_read_b64_tr_b16 a[228:229], v198 offset:128
  ds_read_b64_tr_b16 a[230:231], v199 offset:1664
  v_max3_f32 v218, v218, v118, v119
  v_max3_f32 v218, v218, v120, v121
  v_max3_f32 v218, v218, v122, v123
  v_mfma_f32_32x32x16_bf16 v[48:63], a[188:191], v[160:163], v[48:63]
  ds_read_b64_tr_b16 a[208:209], v204 offset:6272
  ds_read_b64_tr_b16 a[210:211], v205 offset:9344
  v_max3_f32 v218, v218, v124, v125
  v_max3_f32 v218, v218, v126, v127
  v_mov_b32 v228, v218
  s_waitcnt lgkmcnt(15)
  v_max3_f32 v232, v232, v233, v234
  s_waitcnt lgkmcnt(10)
  v_mfma_f32_16x16x32_bf16 v[176:179], a[224:227], a[248:251], v[176:179]
  ds_read_b64_tr_b16 a[212:213], v206 offset:6272
  ds_read_b64_tr_b16 a[214:215], v207 offset:9344
  v_permlane32_swap_b32 v228, v218
  v_max_f32 v218, v218, v228
  v_add_f32 v228, s48, v214
  v_max_f32 v232, v232, v235
  buffer_load_dwordx4 v194, s[32:35], s44 offen offset:2048 nt lds
  v_mfma_f32_32x32x16_bf16 v[64:79], a[192:195], v[160:163], v[64:79]
  ds_read_b64_tr_b16 a[216:217], v204 offset:6400
  ds_read_b64_tr_b16 a[218:219], v205 offset:9472
  v_cmp_gt_f32 s[50:51], v218, v228
  v_mov_b32 v229, v215
  s_nop 0
  v_cndmask_b32 v214, v214, v218, s[50:51]
  v_mul_f32 v232, s47, v232
  s_waitcnt lgkmcnt(10)
  v_mfma_f32_32x32x16_bf16 v[80:95], a[196:199], v[160:163], v[80:95]
  ds_read_b64_tr_b16 a[220:221], v206 offset:6400
  ds_read_b64_tr_b16 a[222:223], v207 offset:9472
  v_mul_f32 v215, s47, v214
  v_sub_f32 v217, v229, v215
  v_exp_f32 v217, v217
  v_max_f32 v232, v232, v219
  v_mfma_f32_32x32x16_bf16 v[0:15], a[200:203], v[164:167], v[0:15]
  ds_read_b64_tr_b16 a[232:233], v198 offset:256
  ds_read_b64_tr_b16 a[234:235], v199 offset:1792
  v_mul_f32 v216, v216, v217
  v_fma_f32 v96, v96, s47, -v215
  v_sub_f32 v221, v219, v232
  v_exp_f32 v221, v221
  s_add_u32 m0, s42, 3072
  s_waitcnt lgkmcnt(10)
  v_mfma_f32_32x32x16_bf16 v[16:31], a[204:207], v[164:167], v[16:31]
  ds_read_b64_tr_b16 a[176:177], v204 offset:12288
  ds_read_b64_tr_b16 a[178:179], v205 offset:15360
  v_exp_f32 v96, v96
  v_fma_f32 v97, v97, s47, -v215
  v_exp_f32 v97, v97
  v_mov_b32 v219, v232
  v_mfma_f32_16x16x32_bf16 v[180:183], a[228:231], a[248:251], v[180:183]
  ds_read_b64_tr_b16 a[180:181], v206 offset:12288
  ds_read_b64_tr_b16 a[182:183], v207 offset:15360
  v_add_f32 v216, v216, v96
  v_fma_f32 v98, v98, s47, -v215
  v_exp_f32 v98, v98
  v_mul_f32 v220, v220, v221
  s_waitcnt lgkmcnt(10)
  v_mfma_f32_32x32x16_bf16 v[32:47], a[208:211], v[164:167], v[32:47]
  ds_read_b64_tr_b16 a[184:185], v204 offset:12416
  ds_read_b64_tr_b16 a[186:187], v205 offset:15488
  v_add_f32 v216, v216, v97
  v_fma_f32 v99, v99, s47, -v215
  v_exp_f32 v99, v99
  v_fma_f32 v188, v188, s47, -v219
  buffer_load_dwordx4 v195, s[32:35], s44 offen offset:0 nt lds
  v_mfma_f32_32x32x16_bf16 v[48:63], a[212:215], v[164:167], v[48:63]
  ds_read_b64_tr_b16 a[188:189], v206 offset:12416
  ds_read_b64_tr_b16 a[190:191], v207 offset:15488
  v_add_f32 v216, v216, v98
  v_fma_f32 v100, v100, s47, -v215
  v_exp_f32 v100, v100
  v_exp_f32 v188, v188
  v_fma_f32 v189, v189, s47, -v219
  s_waitcnt lgkmcnt(10)
  v_mfma_f32_32x32x16_bf16 v[64:79], a[216:219], v[164:167], v[64:79]
  ds_read_b64_tr_b16 a[236:237], v198 offset:12288
  ds_read_b64_tr_b16 a[238:239], v199 offset:13824
  v_add_f32 v216, v216, v99
  v_fma_f32 v101, v101, s47, -v215
  v_exp_f32 v101, v101
  v_exp_f32 v189, v189
  v_mfma_f32_32x32x16_bf16 v[80:95], a[220:223], v[164:167], v[80:95]
  ds_read_b64_tr_b16 a[192:193], v204 offset:12544
  ds_read_b64_tr_b16 a[194:195], v205 offset:15616
  v_add_f32 v216, v216, v100
  v_add_f32 v216, v216, v101
  v_add_f32 v220, v220, v188
  buffer_load_dwordx4 v196, s[32:35], s44 offen offset:1024 nt lds
  s_waitcnt lgkmcnt(10)
  v_mfma_f32_16x16x32_bf16 v[184:187], a[232:235], a[248:251], v[184:187]
  ds_read_b64_tr_b16 a[196:197], v206 offset:12544
  ds_read_b64_tr_b16 a[198:199], v207 offset:15616
  v_fma_f32 v102, v102, s47, -v215
  v_exp_f32 v102, v102
  v_fma_f32 v103, v103, s47, -v215
  v_fma_f32 v190, v190, s47, -v219
  v_mfma_f32_32x32x16_bf16 v[0:15], a[176:179], v[168:171], v[0:15]
  ds_read_b64_tr_b16 a[200:201], v204 offset:18432
  ds_read_b64_tr_b16 a[202:203], v205 offset:21504
  v_exp_f32 v103, v103
  v_add_f32 v216, v216, v102
  v_fma_f32 v104, v104, s47, -v215
  v_exp_f32 v190, v190
  v_add_f32 v220, v220, v189
  s_waitcnt lgkmcnt(10)
  v_mfma_f32_32x32x16_bf16 v[16:31], a[180:183], v[168:171], v[16:31]
  ds_read_b64_tr_b16 a[204:205], v206 offset:18432
  ds_read_b64_tr_b16 a[206:207], v207 offset:21504
  v_exp_f32 v104, v104
  v_add_f32 v216, v216, v103
  v_fma_f32 v191, v191, s47, -v219
  buffer_load_dwordx4 v197, s[32:35], s44 offen offset:2048 nt lds
  v_mfma_f32_32x32x16_bf16 v[32:47], a[184:187], v[168:171], v[32:47]
  ds_read_b64_tr_b16 a[240:241], v198 offset:12416
  ds_read_b64_tr_b16 a[242:243], v199 offset:13952
  v_fma_f32 v105, v105, s47, -v215
  v_exp_f32 v105, v105
  v_add_f32 v216, v216, v104
  v_exp_f32 v191, v191
  s_waitcnt lgkmcnt(10)
  v_mfma_f32_32x32x16_bf16 v[48:63], a[188:191], v[168:171], v[48:63]
  ds_read_b64_tr_b16 a[208:209], v204 offset:18560
  ds_read_b64_tr_b16 a[210:211], v205 offset:21632
  v_fma_f32 v106, v106, s47, -v215
  v_exp_f32 v106, v106
  v_add_f32 v220, v220, v190
  v_mfma_f32_16x16x32_bf16 v[176:179], a[236:239], a[252:255], v[176:179]
  ds_read_b64_tr_b16 a[212:213], v206 offset:18560
  ds_read_b64_tr_b16 a[214:215], v207 offset:21632
  v_add_f32 v216, v216, v105
  v_fma_f32 v107, v107, s47, -v215
  v_exp_f32 v107, v107
  v_add_f32 v220, v220, v191
  v_cvt_pk_bf16_f32 v232, v188, v189
  s_waitcnt lgkmcnt(10)
  v_mfma_f32_32x32x16_bf16 v[64:79], a[192:195], v[168:171], v[64:79]
  ds_read_b64_tr_b16 a[216:217], v204 offset:18688
  ds_read_b64_tr_b16 a[218:219], v205 offset:21760
  v_add_f32 v216, v216, v106
  v_fma_f32 v108, v108, s47, -v215
  v_cvt_pk_bf16_f32 v233, v190, v191
  v_mfma_f32_32x32x16_bf16 v[80:95], a[196:199], v[168:171], v[80:95]
  s_add_u32 s45, s45, 1
  s_cmp_lg_u32 s45, 7
  s_cbranch_scc1 LI1
  ds_read_b64_tr_b16 a[220:221], v206 offset:18688
  ds_read_b64_tr_b16 a[222:223], v207 offset:21760
  v_exp_f32 v108, v108
  v_add_f32 v216, v216, v107
  v_fma_f32 v109, v109, s47, -v215
  ds_write_b64 v222, v[232:233] offset:6144
  s_waitcnt lgkmcnt(11)
  v_mfma_f32_32x32x16_bf16 v[0:15], a[200:203], v[172:175], v[0:15]
  ds_read_b64_tr_b16 a[244:245], v198 offset:12544
  ds_read_b64_tr_b16 a[246:247], v199 offset:14080
  v_exp_f32 v109, v109
  v_add_f32 v216, v216, v108
  v_xor_b32 v222, 0x800, v222
  v_mfma_f32_32x32x16_bf16 v[16:31], a[204:207], v[172:175], v[16:31]
  v_fma_f32 v110, v110, s47, -v215
  v_exp_f32 v110, v110
  v_add_f32 v216, v216, v109
  s_waitcnt lgkmcnt(9)
  v_mfma_f32_16x16x32_bf16 v[180:183], a[240:243], a[252:255], v[180:183]
  v_fma_f32 v111, v111, s47, -v215
  v_exp_f32 v111, v111
  v_mfma_f32_32x32x16_bf16 v[32:47], a[208:211], v[172:175], v[32:47]
  s_add_u32 s42, s39, s37
  s_add_u32 s39, s39, 24576
  s_cmp_eq_u32 s39, 147456
  s_cselect_b32 s39, 0, s39
  v_add_u32 v204, s39, v212
  v_xor_b32 v205, 32, v204
  v_xor_b32 v206, 64, v204
  v_xor_b32 v207, 96, v204
  v_add_u32 v198, s39, v213
  v_xor_b32 v199, 48, v198
  v_xor_b32 v244, 64, v223
  s_waitcnt vmcnt(24) lgkmcnt(0)
  s_barrier
  ds_read_b64_tr_b16 a[176:177], v204 offset:0
  ds_read_b64_tr_b16 a[178:179], v205 offset:3072
  ds_read_b64_tr_b16 a[180:181], v206 offset:0
  ds_read_b64_tr_b16 a[182:183], v207 offset:3072
  v_add_f32 v216, v216, v110
  v_add_f32 v216, v216, v111
  v_cvt_pk_bf16_f32 v160, v96, v97
  v_mfma_f32_32x32x16_bf16 v[48:63], a[212:215], v[172:175], v[48:63]
  ds_read_b64_tr_b16 a[184:185], v204 offset:128
  ds_read_b64_tr_b16 a[186:187], v205 offset:3200
  ds_read_b64_tr_b16 a[188:189], v206 offset:128
  ds_read_b64_tr_b16 a[190:191], v207 offset:3200
  v_cvt_pk_bf16_f32 v161, v98, v99
  v_cvt_pk_bf16_f32 v162, v100, v101
  s_mov_b32 s43, 256
  v_mfma_f32_32x32x16_bf16 v[64:79], a[216:219], v[172:175], v[64:79]
  ds_read_b64_tr_b16 a[192:193], v204 offset:256
  ds_read_b64_tr_b16 a[194:195], v205 offset:3328
  v_cvt_pk_bf16_f32 v163, v102, v103
  v_cvt_pk_bf16_f32 v164, v104, v105
  v_cvt_pk_bf16_f32 v165, v106, v107
  v_mfma_f32_32x32x16_bf16 v[80:95], a[220:223], v[172:175], v[80:95]
  ds_read_b64_tr_b16 a[196:197], v206 offset:256
  ds_read_b64_tr_b16 a[198:199], v207 offset:3328
  v_cvt_pk_bf16_f32 v166, v108, v109
  v_cvt_pk_bf16_f32 v167, v110, v111
  s_add_u32 m0, s42, 0
  v_mfma_f32_16x16x32_bf16 v[184:187], a[244:247], a[252:255], v[184:187]
  ds_read_b64_tr_b16 a[200:201], v204 offset:6144
  ds_read_b64_tr_b16 a[202:203], v205 offset:9216
  v_fma_f32 v112, v112, s47, -v215
  v_exp_f32 v112, v112
  v_fma_f32 v113, v113, s47, -v215
  v_exp_f32 v113, v113
  v_add_f32 v216, v216, v112
  s_cmp_lg_u64 s[50:51], 0
  s_cbranch_scc1 RARE1_7
RET1_7:
  s_waitcnt lgkmcnt(10)
  v_mfma_f32_32x32x16_bf16 v[0:15], a[176:179], v[160:163], v[0:15]
  ds_read_b64_tr_b16 a[204:205], v206 offset:6144
  ds_read_b64_tr_b16 a[206:207], v207 offset:9216
  v_fma_f32 v114, v114, s47, -v215
  v_exp_f32 v114, v114
  v_add_f32 v216, v216, v113
  v_fma_f32 v115, v115, s47, -v215
  v_exp_f32 v115, v115
  v_mfma_f32_32x32x16_bf16 v[16:31], a[180:183], v[160:163], v[16:31]
  ds_read_b64_tr_b16 a[208:209], v204 offset:6272
  ds_read_b64_tr_b16 a[210:211], v205 offset:9344
  buffer_load_dwordx4 v192, s[20:23], s43 offen offset:0 lds
  v_add_f32 v216, v216, v114
  v_fma_f32 v116, v116, s47, -v215
  v_exp_f32 v116, v116
  v_add_f32 v216, v216, v115
  s_waitcnt lgkmcnt(10)
  v_mfma_f32_32x32x16_bf16 v[32:47], a[184:187], v[160:163], v[32:47]
  ds_read_b64_tr_b16 a[212:213], v206 offset:6272
  ds_read_b64_tr_b16 a[214:215], v207 offset:9344
  v_fma_f32 v117, v117, s47, -v215
  v_exp_f32 v117, v117
  v_add_f32 v216, v216, v116
  v_fma_f32 v118, v118, s47, -v215
  v_exp_f32 v118, v118
  v_mfma_f32_32x32x16_bf16 v[48:63], a[188:191], v[160:163], v[48:63]
  ds_read_b64_tr_b16 a[216:217], v204 offset:6400
  ds_read_b64_tr_b16 a[218:219], v205 offset:9472
  buffer_load_dwordx4 v193, s[20:23], s43 offen offset:1024 lds
  v_add_f32 v216, v216, v117
  v_fma_f32 v119, v119, s47, -v215
  v_exp_f32 v119, v119
  v_add_f32 v216, v216, v118
  v_fma_f32 v120, v120, s47, -v215
  v_mul_f32 v176, v176, v221
  v_mul_f32 v177, v177, v221
  s_waitcnt lgkmcnt(10)
  v_mfma_f32_32x32x16_bf16 v[64:79], a[192:195], v[160:163], v[64:79]
  ds_read_b64_tr_b16 a[220:221], v206 offset:6400
  ds_read_b64_tr_b16 a[222:223], v207 offset:9472
  v_exp_f32 v120, v120
  v_add_f32 v216, v216, v119
  v_fma_f32 v121, v121, s47, -v215
  v_exp_f32 v121, v121
  v_mul_f32 v178, v178, v221
  v_mfma_f32_32x32x16_bf16 v[80:95], a[196:199], v[160:163], v[80:95]
  ds_read_b64_tr_b16 a[176:177], v204 offset:12288
  ds_read_b64_tr_b16 a[178:179], v205 offset:15360
  v_add_f32 v216, v216, v120
  v_fma_f32 v122, v122, s47, -v215
  v_exp_f32 v122, v122
  v_add_f32 v216, v216, v121
  v_fma_f32 v123, v123, s47, -v215
  v_mul_f32 v179, v179, v221
  v_mul_f32 v180, v180, v221
  s_waitcnt lgkmcnt(10)
  v_mfma_f32_32x32x16_bf16 v[0:15], a[200:203], v[164:167], v[0:15]
  ds_read_b128 a[248:251], v223 offset:6144
  ds_read_b128 a[252:255], v244 offset:6144
  v_xor_b32 v223, 0x800, v223
  ds_read_b64_tr_b16 a[224:225], v198 offset:0
  ds_read_b64_tr_b16 a[226:227], v199 offset:1536
  buffer_load_dwordx4 v194, s[20:23], s43 offen offset:2048 lds
  v_exp_f32 v123, v123
  v_add_f32 v216, v216, v122
  v_fma_f32 v124, v124, s47, -v215
  v_exp_f32 v124, v124
  v_add_f32 v216, v216, v123
  v_mul_f32 v181, v181, v221
  v_mfma_f32_32x32x16_bf16 v[16:31], a[204:207], v[164:167], v[16:31]
  ds_read_b64_tr_b16 a[180:181], v206 offset:12288
  ds_read_b64_tr_b16 a[182:183], v207 offset:15360
  v_fma_f32 v125, v125, s47, -v215
  v_exp_f32 v125, v125
  v_add_f32 v216, v216, v124
  v_fma_f32 v126, v126, s47, -v215
  v_mul_f32 v182, v182, v221
  v_mul_f32 v183, v183, v221
  s_waitcnt lgkmcnt(12)
  v_mfma_f32_32x32x16_bf16 v[32:47], a[208:211], v[164:167], v[32:47]
  ds_read_b64_tr_b16 a[184:185], v204 offset:12416
  ds_read_b64_tr_b16 a[186:187], v205 offset:15488
  s_add_u32 m0, s42, 3072
  v_exp_f32 v126, v126
  v_add_f32 v216, v216, v125
  v_fma_f32 v127, v127, s47, -v215
  v_exp_f32 v127, v127
  v_add_f32 v216, v216, v126
  v_mul_f32 v184, v184, v221
  v_mfma_f32_32x32x16_bf16 v[48:63], a[212:215], v[164:167], v[48:63]
  ds_read_b64_tr_b16 a[228:229], v198 offset:128
  ds_read_b64_tr_b16 a[230:231], v199 offset:1664
  v_add_f32 v216, v216, v127
  v_cvt_pk_bf16_f32 v168, v112, v113
  v_cvt_pk_bf16_f32 v169, v114, v115
  v_cvt_pk_bf16_f32 v170, v116, v117
  v_cvt_pk_bf16_f32 v171, v118, v119
  v_mul_f32 v185, v185, v221
  v_mul_f32 v186, v186, v221
  s_waitcnt lgkmcnt(12)
  v_mfma_f32_32x32x16_bf16 v[64:79], a[216:219], v[164:167], v[64:79]
  ds_read_b64_tr_b16 a[188:189], v206 offset:12416
  ds_read_b64_tr_b16 a[190:191], v207 offset:15488
  v_cvt_pk_bf16_f32 v172, v120, v121
  v_cvt_pk_bf16_f32 v173, v122, v123
  v_cvt_pk_bf16_f32 v174, v124, v125
  v_cvt_pk_bf16_f32 v175, v126, v127
  v_mul_f32 v187, v187, v221
  v_mfma_f32_32x32x16_bf16 v[80:95], a[220:223], v[164:167], v[80:95]
  ds_read_b64_tr_b16 a[192:193], v204 offset:12544
  ds_read_b64_tr_b16 a[194:195], v205 offset:15616
  buffer_load_dwordx4 v195, s[20:23], s43 offen offset:0 lds
  s_waitcnt lgkmcnt(10)
  v_mfma_f32_32x32x16_bf16 v[0:15], a[176:179], v[168:171], v[0:15]
  ds_read_b64_tr_b16 a[232:233], v198 offset:256
  ds_read_b64_tr_b16 a[234:235], v199 offset:1792
  v_mfma_f32_16x16x32_bf16 v[176:179], a[224:227], a[248:251], v[176:179]
  ds_read_b64_tr_b16 a[196:197], v206 offset:12544
  ds_read_b64_tr_b16 a[198:199], v207 offset:15616
  buffer_load_dwordx4 v196, s[20:23], s43 offen offset:1024 lds
  v_mov_b32 v231, v220
  s_nop 1
  v_permlane16_swap_b32 v231, v220
  s_waitcnt lgkmcnt(10)
  v_mfma_f32_32x32x16_bf16 v[16:31], a[180:183], v[168:171], v[16:31]
  ds_read_b64_tr_b16 a[200:201], v204 offset:18432
  ds_read_b64_tr_b16 a[202:203], v205 offset:21504
  v_add_f32 v220, v220, v231
  v_mfma_f32_32x32x16_bf16 v[32:47], a[184:187], v[168:171], v[32:47]
  ds_read_b64_tr_b16 a[236:237], v198 offset:12288
  ds_read_b64_tr_b16 a[238:239], v199 offset:13824
  v_mov_b32 v231, v220
  s_waitcnt lgkmcnt(10)
  v_mfma_f32_16x16x32_bf16 v[180:183], a[228:231], a[248:251], v[180:183]
  ds_read_b64_tr_b16 a[204:205], v206 offset:18432
  ds_read_b64_tr_b16 a[206:207], v207 offset:21504
  buffer_load_dwordx4 v197, s[20:23], s43 offen offset:2048 lds
  v_permlane32_swap_b32 v231, v220
  v_mfma_f32_32x32x16_bf16 v[48:63], a[188:191], v[168:171], v[48:63]
  ds_read_b64_tr_b16 a[208:209], v204 offset:18560
  ds_read_b64_tr_b16 a[210:211], v205 offset:21632
  v_add_f32 v220, v220, v231
  s_waitcnt lgkmcnt(10)
  v_mfma_f32_32x32x16_bf16 v[64:79], a[192:195], v[168:171], v[64:79]
  ds_read_b64_tr_b16 a[240:241], v198 offset:12416
  ds_read_b64_tr_b16 a[242:243], v199 offset:13952
  ds_write_b32 v224, v220 offset:512
  v_mfma_f32_16x16x32_bf16 v[184:187], a[232:235], a[248:251], v[184:187]
  ds_read_b64_tr_b16 a[212:213], v206 offset:18560
  ds_read_b64_tr_b16 a[214:215], v207 offset:21632
  v_mov_b32 v228, v216
  v_accvgpr_read_b32 v210, a174
  s_waitcnt lgkmcnt(11)
  v_mfma_f32_32x32x16_bf16 v[80:95], a[196:199], v[168:171], v[80:95]
  ds_read_b64_tr_b16 a[216:217], v204 offset:18688
  ds_read_b64_tr_b16 a[218:219], v205 offset:21760
  v_permlane32_swap_b32 v228, v216
  v_accvgpr_read_b32 v211, a175
  v_mfma_f32_32x32x16_bf16 v[0:15], a[200:203], v[172:175], v[0:15]
  ds_read_b64_tr_b16 a[244:245], v198 offset:12544
  ds_read_b64_tr_b16 a[246:247], v199 offset:14080
  v_add_f32 v216, v216, v228
  s_waitcnt lgkmcnt(11)
  v_mfma_f32_16x16x32_bf16 v[176:179], a[236:239], a[252:255], v[176:179]
  ds_read_b64_tr_b16 a[220:221], v206 offset:18688
  ds_read_b64_tr_b16 a[222:223], v207 offset:21760
  v_rcp_f32 v217, v216
  v_mfma_f32_32x32x16_bf16 v[16:31], a[204:207], v[172:175], v[16:31]
  s_waitcnt lgkmcnt(9)
  v_mfma_f32_32x32x16_bf16 v[32:47], a[208:211], v[172:175], v[32:47]
  v_mfma_f32_16x16x32_bf16 v[180:183], a[240:243], a[252:255], v[180:183]
  s_add_u32 s42, s39, s37
  s_add_u32 s39, s39, 24576
  s_cmp_eq_u32 s39, 147456
  s_cselect_b32 s39, 0, s39
  v_add_u32 v200, s39, v210
  v_xor_b32 v201, 128, v200
  v_xor_b32 v202, 32, v200
  v_xor_b32 v203, 160, v200
  v_xor_b32 v204, 64, v200
  v_xor_b32 v205, 192, v200
  v_xor_b32 v206, 96, v200
  v_xor_b32 v207, 224, v200
  v_add_u32 v208, s39, v211
  v_xor_b32 v244, 64, v227
  s_waitcnt vmcnt(24) lgkmcnt(0)
  s_barrier
  ds_read_b64_tr_b16 a[176:177], v200 offset:0
  ds_read_b64_tr_b16 a[178:179], v201 offset:2048
  ds_read_b64_tr_b16 a[180:181], v200 offset:4096
  ds_read_b64_tr_b16 a[182:183], v201 offset:6144
  v_mfma_f32_32x32x16_bf16 v[48:63], a[212:215], v[172:175], v[48:63]
  ds_read_b64_tr_b16 a[184:185], v200 offset:8192
  ds_read_b64_tr_b16 a[186:187], v201 offset:10240
  ds_read_b64_tr_b16 a[188:189], v200 offset:12288
  ds_read_b64_tr_b16 a[190:191], v201 offset:14336
  s_add_u32 s43, s54, 123136
  ds_read_b128 v[232:235], v225 offset:512
  v_mfma_f32_32x32x16_bf16 v[64:79], a[216:219], v[172:175], v[64:79]
  ds_read_b128 a[96:99], v227 offset:0
  ds_read_b64_tr_b16 a[224:225], v208 offset:0
  ds_read_b64_tr_b16 a[226:227], v208 offset:1024
  s_cmp_ge_u32 s54, 1024
  v_mfma_f32_16x16x32_bf16 v[184:187], a[244:247], a[252:255], v[184:187]
  ds_read_b64_tr_b16 a[192:193], v200 offset:16384
  ds_read_b64_tr_b16 a[194:195], v201 offset:18432
  v_mfma_f32_32x32x16_bf16 v[80:95], a[220:223], v[172:175], v[80:95]
  ds_read_b64_tr_b16 a[196:197], v200 offset:20480
  ds_read_b64_tr_b16 a[198:199], v201 offset:22528
  s_cselect_b32 s43, 0x10000000, s43
  s_add_u32 m0, s42, 0
  s_waitcnt lgkmcnt(12)
  v_mfma_f32_32x32x16_bf16 v[96:111], a[176:179], a[0:3], 0
  ds_read_b64_tr_b16 a[200:201], v202 offset:0
  ds_read_b64_tr_b16 a[202:203], v203 offset:2048
  v_mfma_f32_32x32x16_bf16 v[96:111], a[180:183], a[4:7], v[96:111]
  ds_read_b64_tr_b16 a[204:205], v202 offset:4096
  ds_read_b64_tr_b16 a[206:207], v203 offset:6144
  buffer_load_dwordx4 v192, s[20:23], s43 offen offset:0 lds
  v_mul_f32 v0, v0, v217
  v_mul_f32 v1, v1, v217
  v_cvt_pk_bf16_f32 v0, v0, v1
  s_waitcnt lgkmcnt(11)
  v_add_f32 v232, v232, v233
  v_mfma_f32_32x32x16_bf16 v[96:111], a[184:187], a[8:11], v[96:111]
  ds_read_b128 a[100:103], v244 offset:0
  ds_read_b64_tr_b16 a[228:229], v208 offset:8192
  ds_read_b64_tr_b16 a[230:231], v208 offset:9216
  v_mul_f32 v2, v2, v217
  v_mul_f32 v3, v3, v217
  v_cvt_pk_bf16_f32 v1, v2, v3
  v_add_f32 v234, v234, v235
  v_mfma_f32_32x32x16_bf16 v[96:111], a[188:191], a[12:15], v[96:111]
  ds_read_b64_tr_b16 a[208:209], v202 offset:8192
  ds_read_b64_tr_b16 a[210:211], v203 offset:10240
  v_mul_f32 v4, v4, v217
  v_mul_f32 v5, v5, v217
  v_add_f32 v232, v232, v234
  v_rcp_f32 v221, v232
  s_waitcnt lgkmcnt(11)
  v_mfma_f32_16x16x32_bf16 v[160:163], a[224:227], a[96:99], 0
  ds_read_b64_tr_b16 a[212:213], v202 offset:12288
  ds_read_b64_tr_b16 a[214:215], v203 offset:14336
  buffer_load_dwordx4 v193, s[20:23], s43 offen offset:1024 lds
  v_cvt_pk_bf16_f32 v2, v4, v5
  v_mul_f32 v6, v6, v217
  v_mul_f32 v7, v7, v217
  v_mul_f32 v176, v176, v221
  v_mfma_f32_32x32x16_bf16 v[96:111], a[192:195], a[16:19], v[96:111]
  ds_read_b64_tr_b16 a[216:217], v202 offset:16384
  ds_read_b64_tr_b16 a[218:219], v203 offset:18432
  v_cvt_pk_bf16_f32 v3, v6, v7
  v_mul_f32 v8, v8, v217
  v_mul_f32 v177, v177, v221
  s_waitcnt lgkmcnt(11)
  v_mfma_f32_32x32x16_bf16 v[96:111], a[196:199], a[20:23], v[96:111]
  ds_read_b64_tr_b16 a[220:221], v202 offset:20480
  ds_read_b64_tr_b16 a[222:223], v203 offset:22528
  buffer_load_dwordx4 v194, s[20:23], s43 offen offset:2048 lds
  v_mul_f32 v9, v9, v217
  v_cvt_pk_bf16_f32 v4, v8, v9
  v_mul_f32 v10, v10, v217
  v_mul_f32 v178, v178, v221
  v_mul_f32 v179, v179, v221
  v_mfma_f32_32x32x16_bf16 v[112:127], a[200:203], a[0:3], 0
  ds_read_b128 a[104:107], v227 offset:128
  ds_read_b64_tr_b16 a[232:233], v208 offset:16384
  ds_read_b64_tr_b16 a[234:235], v208 offset:17408
  v_mul_f32 v11, v11, v217
  v_cvt_pk_bf16_f32 v5, v10, v11
  v_mul_f32 v180, v180, v221
  s_waitcnt lgkmcnt(11)
  v_mfma_f32_32x32x16_bf16 v[112:127], a[204:207], a[4:7], v[112:127]
  ds_read_b64_tr_b16 a[176:177], v204 offset:0
  ds_read_b64_tr_b16 a[178:179], v205 offset:2048
  v_mul_f32 v12, v12, v217
  v_mul_f32 v13, v13, v217
  v_cvt_pk_bf16_f32 v6, v12, v13
  v_mul_f32 v181, v181, v221
  s_waitcnt lgkmcnt(11)
  v_mfma_f32_16x16x32_bf16 v[160:163], a[228:231], a[100:103], v[160:163]
  ds_read_b64_tr_b16 a[180:181], v204 offset:4096
  ds_read_b64_tr_b16 a[182:183], v205 offset:6144
  s_add_u32 m0, s42, 3072
  v_mul_f32 v14, v14, v217
  v_mul_f32 v15, v15, v217
  v_cvt_pk_bf16_f32 v7, v14, v15
  v_mul_f32 v182, v182, v221
  v_mul_f32 v183, v183, v221
  v_mfma_f32_32x32x16_bf16 v[112:127], a[208:211], a[8:11], v[112:127]
  ds_read_b64_tr_b16 a[184:185], v204 offset:8192
  ds_read_b64_tr_b16 a[186:187], v205 offset:10240
  v_mul_f32 v16, v16, v217
  v_mul_f32 v17, v17, v217
  v_mul_f32 v184, v184, v221
  s_waitcnt lgkmcnt(11)
  v_mfma_f32_32x32x16_bf16 v[112:127], a[212:215], a[12:15], v[112:127]
  ds_read_b64_tr_b16 a[188:189], v204 offset:12288
  ds_read_b64_tr_b16 a[190:191], v205 offset:14336
  buffer_load_dwordx4 v195, s[20:23], s43 offen offset:0 lds
  v_cvt_pk_bf16_f32 v8, v16, v17
  v_mul_f32 v18, v18, v217
  v_mul_f32 v19, v19, v217
  v_mul_f32 v185, v185, v221
  v_mul_f32 v186, v186, v221
  v_mfma_f32_32x32x16_bf16 v[112:127], a[216:219], a[16:19], v[112:127]
  ds_read_b64_tr_b16 a[236:237], v208 offset:8
  ds_read_b64_tr_b16 a[238:239], v208 offset:1032
  v_cvt_pk_bf16_f32 v9, v18, v19
  v_mul_f32 v20, v20, v217
  v_mul_f32 v187, v187, v221
  s_waitcnt lgkmcnt(10)
  v_mfma_f32_32x32x16_bf16 v[112:127], a[220:223], a[20:23], v[112:127]
  ds_read_b64_tr_b16 a[192:193], v204 offset:16384
  ds_read_b64_tr_b16 a[194:195], v205 offset:18432
  v_mul_f32 v21, v21, v217
  v_cvt_pk_bf16_f32 v10, v20, v21
  v_mul_f32 v22, v22, v217
  v_cvt_pk_bf16_f32 v176, v176, v177
  s_waitcnt lgkmcnt(10)
  v_mfma_f32_16x16x32_bf16 v[160:163], a[232:235], a[104:107], v[160:163]
  ds_read_b64_tr_b16 a[196:197], v204 offset:20480
  ds_read_b64_tr_b16 a[198:199], v205 offset:22528
  buffer_load_dwordx4 v196, s[20:23], s43 offen offset:1024 lds
  v_mul_f32 v23, v23, v217
  v_cvt_pk_bf16_f32 v11, v22, v23
  v_cvt_pk_bf16_f32 v177, v178, v179
  ds_write_b64 v226, v[176:177] offset:6144
  v_mfma_f32_32x32x16_bf16 v[128:143], a[176:179], a[0:3], 0
  ds_read_b64_tr_b16 a[200:201], v206 offset:0
  ds_read_b64_tr_b16 a[202:203], v207 offset:2048
  v_mul_f32 v24, v24, v217
  v_mul_f32 v25, v25, v217
  v_cvt_pk_bf16_f32 v12, v24, v25
  v_cvt_pk_bf16_f32 v180, v180, v181
  s_waitcnt lgkmcnt(11)
  v_mfma_f32_32x32x16_bf16 v[128:143], a[180:183], a[4:7], v[128:143]
  ds_read_b64_tr_b16 a[204:205], v206 offset:4096
  ds_read_b64_tr_b16 a[206:207], v207 offset:6144
  buffer_load_dwordx4 v197, s[20:23], s43 offen offset:2048 lds
  v_mul_f32 v26, v26, v217
  v_mul_f32 v27, v27, v217
  v_cvt_pk_bf16_f32 v13, v26, v27
  v_cvt_pk_bf16_f32 v181, v182, v183
  v_mfma_f32_32x32x16_bf16 v[128:143], a[184:187], a[8:11], v[128:143]
  ds_read_b64_tr_b16 a[240:241], v208 offset:8200
  ds_read_b64_tr_b16 a[242:243], v208 offset:9224
  v_mul_f32 v28, v28, v217
  v_mul_f32 v29, v29, v217
  ds_write_b64 v226, v[180:181] offset:6272
  v_cvt_pk_bf16_f32 v184, v184, v185
  s_waitcnt lgkmcnt(12)
  v_mfma_f32_32x32x16_bf16 v[128:143], a[188:191], a[12:15], v[128:143]
  ds_read_b64_tr_b16 a[208:209], v206 offset:8192
  ds_read_b64_tr_b16 a[210:211], v207 offset:10240
  v_cvt_pk_bf16_f32 v14, v28, v29
  v_mul_f32 v30, v30, v217
  v_mul_f32 v31, v31, v217
  v_cvt_pk_bf16_f32 v185, v186, v187
  s_waitcnt lgkmcnt(12)
  v_mfma_f32_16x16x32_bf16 v[164:167], a[236:239], a[96:99], 0
  ds_read_b64_tr_b16 a[212:213], v206 offset:12288
  ds_read_b64_tr_b16 a[214:215], v207 offset:14336
  v_cvt_pk_bf16_f32 v15, v30, v31
  v_mul_f32 v32, v32, v217
  ds_write_b64 v226, v[184:185] offset:6400
  v_mfma_f32_32x32x16_bf16 v[128:143], a[192:195], a[16:19], v[128:143]
  ds_read_b64_tr_b16 a[216:217], v206 offset:16384
  ds_read_b64_tr_b16 a[218:219], v207 offset:18432
  v_mul_f32 v33, v33, v217
  v_cvt_pk_bf16_f32 v16, v32, v33
  v_mul_f32 v34, v34, v217
  s_waitcnt lgkmcnt(12)
  v_mfma_f32_32x32x16_bf16 v[128:143], a[196:199], a[20:23], v[128:143]
  ds_read_b64_tr_b16 a[220:221], v206 offset:20480
  ds_read_b64_tr_b16 a[222:223], v207 offset:22528
  s_add_u32 s42, s39, s37
  s_add_u32 s39, s39, 24576
  s_cmp_eq_u32 s39, 147456
  s_cselect_b32 s39, 0, s39
  v_mul_f32 v35, v35, v217
  v_cvt_pk_bf16_f32 v17, v34, v35
  v_mfma_f32_32x32x16_bf16 v[144:159], a[200:203], a[0:3], 0
  ds_read_b64_tr_b16 a[244:245], v208 offset:16392
  ds_read_b64_tr_b16 a[246:247], v208 offset:17416
  v_add_u32 v228, s39, v210
  v_xor_b32 v229, 128, v228
  v_mul_f32 v36, v36, v217
  v_mul_f32 v37, v37, v217
  v_cvt_pk_bf16_f32 v18, v36, v37
  s_waitcnt lgkmcnt(12)
  v_mfma_f32_32x32x16_bf16 v[144:159], a[204:207], a[4:7], v[144:159]
  v_xor_b32 v230, 32, v228
  v_xor_b32 v231, 160, v228
  v_xor_b32 v232, 64, v228
  v_xor_b32 v233, 192, v228
  v_mul_f32 v38, v38, v217
  v_mul_f32 v39, v39, v217
  v_cvt_pk_bf16_f32 v19, v38, v39
  s_waitcnt lgkmcnt(9)
  v_mfma_f32_16x16x32_bf16 v[164:167], a[240:243], a[100:103], v[164:167]
  v_xor_b32 v234, 96, v228
  v_xor_b32 v235, 224, v228
  v_add_u32 v236, s39, v211
  v_mfma_f32_32x32x16_bf16 v[144:159], a[208:211], a[8:11], v[144:159]
  s_waitcnt vmcnt(24) lgkmcnt(0)
  s_barrier
  ds_read_b64_tr_b16 a[176:177], v228 offset:0
  ds_read_b64_tr_b16 a[178:179], v229 offset:2048
  ds_read_b64_tr_b16 a[180:181], v228 offset:4096
  ds_read_b64_tr_b16 a[182:183], v229 offset:6144
  v_mul_f32 v40, v40, v217
  v_mul_f32 v41, v41, v217
  v_cvt_pk_bf16_f32 v20, v40, v41
  v_mul_f32 v42, v42, v217
  v_mul_f32 v43, v43, v217
  v_mfma_f32_32x32x16_bf16 v[144:159], a[212:215], a[12:15], v[144:159]
  ds_read_b64_tr_b16 a[184:185], v228 offset:8192
  ds_read_b64_tr_b16 a[186:187], v229 offset:10240
  ds_read_b64_tr_b16 a[188:189], v228 offset:12288
  ds_read_b64_tr_b16 a[190:191], v229 offset:14336
  v_cvt_pk_bf16_f32 v21, v42, v43
  v_mul_f32 v44, v44, v217
  s_add_u32 s43, s54, 246016
  v_mfma_f32_32x32x16_bf16 v[144:159], a[216:219], a[16:19], v[144:159]
  ds_read_b128 a[108:111], v244 offset:128
  ds_read_b64_tr_b16 a[224:225], v236 offset:0
  ds_read_b64_tr_b16 a[226:227], v236 offset:1024
  v_mul_f32 v45, v45, v217
  v_cvt_pk_bf16_f32 v22, v44, v45
  v_mul_f32 v46, v46, v217
  s_cmp_ge_u32 s54, 1024
  v_mfma_f32_32x32x16_bf16 v[144:159], a[220:223], a[20:23], v[144:159]
  ds_read_b64_tr_b16 a[192:193], v228 offset:16384
  ds_read_b64_tr_b16 a[194:195], v229 offset:18432
  v_mul_f32 v47, v47, v217
  v_cvt_pk_bf16_f32 v23, v46, v47
  s_cselect_b32 s43, 0x10000000, s43
  s_waitcnt lgkmcnt(11)
  v_mfma_f32_16x16x32_bf16 v[164:167], a[244:247], a[104:107], v[164:167]
  ds_read_b64_tr_b16 a[196:197], v228 offset:20480
  ds_read_b64_tr_b16 a[198:199], v229 offset:22528
  s_add_u32 m0, s42, 0
  v_mul_f32 v48, v48, v217
  v_mul_f32 v49, v49, v217
  v_cvt_pk_bf16_f32 v24, v48, v49
  v_mfma_f32_32x32x16_bf16 v[96:111], a[176:179], a[24:27], v[96:111]
  ds_read_b64_tr_b16 a[200:201], v230 offset:0
  ds_read_b64_tr_b16 a[202:203], v231 offset:2048
  v_mul_f32 v50, v50, v217
  v_mul_f32 v51, v51, v217
  s_waitcnt lgkmcnt(11)
  v_mfma_f32_32x32x16_bf16 v[96:111], a[180:183], a[28:31], v[96:111]
  ds_read_b64_tr_b16 a[204:205], v230 offset:4096
  ds_read_b64_tr_b16 a[206:207], v231 offset:6144
  buffer_load_dwordx4 v192, s[20:23], s43 offen offset:0 lds
  v_cvt_pk_bf16_f32 v25, v50, v51
  v_mul_f32 v52, v52, v217
  v_mul_f32 v53, v53, v217
  v_mfma_f32_32x32x16_bf16 v[96:111], a[184:187], a[32:35], v[96:111]
  ds_read_b128 a[112:115], v227 offset:256
  ds_read_b64_tr_b16 a[228:229], v236 offset:8192
  ds_read_b64_tr_b16 a[230:231], v236 offset:9216
  v_cvt_pk_bf16_f32 v26, v52, v53
  v_mul_f32 v54, v54, v217
  s_waitcnt lgkmcnt(11)
  v_mfma_f32_32x32x16_bf16 v[96:111], a[188:191], a[36:39], v[96:111]
  ds_read_b64_tr_b16 a[208:209], v230 offset:8192
  ds_read_b64_tr_b16 a[210:211], v231 offset:10240
  v_mul_f32 v55, v55, v217
  v_cvt_pk_bf16_f32 v27, v54, v55
  v_mul_f32 v56, v56, v217
  s_waitcnt lgkmcnt(11)
  v_mfma_f32_16x16x32_bf16 v[160:163], a[224:227], a[108:111], v[160:163]
  ds_read_b64_tr_b16 a[212:213], v230 offset:12288
  ds_read_b64_tr_b16 a[214:215], v231 offset:14336
  buffer_load_dwordx4 v193, s[20:23], s43 offen offset:1024 lds
  v_mul_f32 v57, v57, v217
  v_cvt_pk_bf16_f32 v28, v56, v57
  v_mfma_f32_32x32x16_bf16 v[96:111], a[192:195], a[40:43], v[96:111]
  ds_read_b64_tr_b16 a[216:217], v230 offset:16384
  ds_read_b64_tr_b16 a[218:219], v231 offset:18432
  v_mul_f32 v58, v58, v217
  v_mul_f32 v59, v59, v217
  v_cvt_pk_bf16_f32 v29, v58, v59
  s_waitcnt lgkmcnt(11)
  v_mfma_f32_32x32x16_bf16 v[96:111], a[196:199], a[44:47], v[96:111]
  ds_read_b64_tr_b16 a[220:221], v230 offset:20480
  ds_read_b64_tr_b16 a[222:223], v231 offset:22528
  buffer_load_dwordx4 v194, s[20:23], s43 offen offset:2048 lds
  v_mul_f32 v60, v60, v217
  v_mul_f32 v61, v61, v217
  v_mfma_f32_32x32x16_bf16 v[112:127], a[200:203], a[24:27], v[112:127]
  ds_read_b128 a[116:119], v244 offset:256
  ds_read_b64_tr_b16 a[232:233], v236 offset:16384
  ds_read_b64_tr_b16 a[234:235], v236 offset:17408
  v_cvt_pk_bf16_f32 v30, v60, v61
  v_mul_f32 v62, v62, v217
  v_mul_f32 v63, v63, v217
  s_waitcnt lgkmcnt(11)
  v_mfma_f32_32x32x16_bf16 v[112:127], a[204:207], a[28:31], v[112:127]
  ds_read_b64_tr_b16 a[176:177], v232 offset:0
  ds_read_b64_tr_b16 a[178:179], v233 offset:2048
  v_cvt_pk_bf16_f32 v31, v62, v63
  v_mul_f32 v64, v64, v217
  s_waitcnt lgkmcnt(11)
  v_mfma_f32_16x16x32_bf16 v[160:163], a[228:231], a[112:115], v[160:163]
  ds_read_b64_tr_b16 a[180:181], v232 offset:4096
  ds_read_b64_tr_b16 a[182:183], v233 offset:6144
  s_add_u32 m0, s42, 3072
  v_mul_f32 v65, v65, v217
  v_cvt_pk_bf16_f32 v32, v64, v65
  v_mul_f32 v66, v66, v217
  v_mfma_f32_32x32x16_bf16 v[112:127], a[208:211], a[32:35], v[112:127]
  ds_read_b64_tr_b16 a[184:185], v232 offset:8192
  ds_read_b64_tr_b16 a[186:187], v233 offset:10240
  v_mul_f32 v67, v67, v217
  v_cvt_pk_bf16_f32 v33, v66, v67
  s_waitcnt lgkmcnt(11)
  v_mfma_f32_32x32x16_bf16 v[112:127], a[212:215], a[36:39], v[112:127]
  ds_read_b64_tr_b16 a[188:189], v232 offset:12288
  ds_read_b64_tr_b16 a[190:191], v233 offset:14336
  buffer_load_dwordx4 v195, s[20:23], s43 offen offset:0 lds
  v_mul_f32 v68, v68, v217
  v_mul_f32 v69, v69, v217
  v_cvt_pk_bf16_f32 v34, v68, v69
  v_mfma_f32_32x32x16_bf16 v[112:127], a[216:219], a[40:43], v[112:127]
  ds_read_b64_tr_b16 a[236:237], v236 offset:8
  ds_read_b64_tr_b16 a[238:239], v236 offset:1032
  v_mul_f32 v70, v70, v217
  v_mul_f32 v71, v71, v217
  s_waitcnt lgkmcnt(10)
  v_mfma_f32_32x32x16_bf16 v[112:127], a[220:223], a[44:47], v[112:127]
  ds_read_b64_tr_b16 a[192:193], v232 offset:16384
  ds_read_b64_tr_b16 a[194:195], v233 offset:18432
  v_cvt_pk_bf16_f32 v35, v70, v71
  v_mul_f32 v72, v72, v217
  v_mul_f32 v73, v73, v217
  s_waitcnt lgkmcnt(10)
  v_mfma_f32_16x16x32_bf16 v[160:163], a[232:235], a[116:119], v[160:163]
  ds_read_b64_tr_b16 a[196:197], v232 offset:20480
  ds_read_b64_tr_b16 a[198:199], v233 offset:22528
  buffer_load_dwordx4 v196, s[20:23], s43 offen offset:1024 lds
  v_cvt_pk_bf16_f32 v36, v72, v73
  v_mul_f32 v74, v74, v217
  v_mfma_f32_32x32x16_bf16 v[128:143], a[176:179], a[24:27], v[128:143]
  ds_read_b64_tr_b16 a[200:201], v234 offset:0
  ds_read_b64_tr_b16 a[202:203], v235 offset:2048
  v_mul_f32 v75, v75, v217
  v_cvt_pk_bf16_f32 v37, v74, v75
  v_mul_f32 v76, v76, v217
  s_waitcnt lgkmcnt(10)
  v_mfma_f32_32x32x16_bf16 v[128:143], a[180:183], a[28:31], v[128:143]
  ds_read_b64_tr_b16 a[204:205], v234 offset:4096
  ds_read_b64_tr_b16 a[206:207], v235 offset:6144
  buffer_load_dwordx4 v197, s[20:23], s43 offen offset:2048 lds
  v_mul_f32 v77, v77, v217
  v_cvt_pk_bf16_f32 v38, v76, v77
  v_mfma_f32_32x32x16_bf16 v[128:143], a[184:187], a[32:35], v[128:143]
  ds_read_b64_tr_b16 a[240:241], v236 offset:8200
  ds_read_b64_tr_b16 a[242:243], v236 offset:9224
  v_mul_f32 v78, v78, v217
  v_mul_f32 v79, v79, v217
  v_cvt_pk_bf16_f32 v39, v78, v79
  s_waitcnt lgkmcnt(10)
  v_mfma_f32_32x32x16_bf16 v[128:143], a[188:191], a[36:39], v[128:143]
  ds_read_b64_tr_b16 a[208:209], v234 offset:8192
  ds_read_b64_tr_b16 a[210:211], v235 offset:10240
  v_mul_f32 v80, v80, v217
  v_mul_f32 v81, v81, v217
  s_waitcnt lgkmcnt(10)
  v_mfma_f32_16x16x32_bf16 v[164:167], a[236:239], a[108:111], v[164:167]
  ds_read_b64_tr_b16 a[212:213], v234 offset:12288
  ds_read_b64_tr_b16 a[214:215], v235 offset:14336
  v_cvt_pk_bf16_f32 v40, v80, v81
  v_mul_f32 v82, v82, v217
  v_mul_f32 v83, v83, v217
  v_mfma_f32_32x32x16_bf16 v[128:143], a[192:195], a[40:43], v[128:143]
  ds_read_b64_tr_b16 a[216:217], v234 offset:16384
  ds_read_b64_tr_b16 a[218:219], v235 offset:18432
  v_cvt_pk_bf16_f32 v41, v82, v83
  v_mul_f32 v84, v84, v217
  s_waitcnt lgkmcnt(10)
  v_mfma_f32_32x32x16_bf16 v[128:143], a[196:199], a[44:47], v[128:143]
  ds_read_b64_tr_b16 a[220:221], v234 offset:20480
  ds_read_b64_tr_b16 a[222:223], v235 offset:22528
  s_add_u32 s42, s39, s37
  s_add_u32 s39, s39, 24576
  s_cmp_eq_u32 s39, 147456
  v_mul_f32 v85, v85, v217
  v_cvt_pk_bf16_f32 v42, v84, v85
  v_mul_f32 v86, v86, v217
  v_mfma_f32_32x32x16_bf16 v[144:159], a[200:203], a[24:27], v[144:159]
  ds_read_b64_tr_b16 a[244:245], v236 offset:16392
  ds_read_b64_tr_b16 a[246:247], v236 offset:17416
  s_cselect_b32 s39, 0, s39
  v_add_u32 v200, s39, v210
  v_xor_b32 v201, 128, v200
  v_mul_f32 v87, v87, v217
  v_cvt_pk_bf16_f32 v43, v86, v87
  s_waitcnt lgkmcnt(10)
  v_mfma_f32_32x32x16_bf16 v[144:159], a[204:207], a[28:31], v[144:159]
  v_xor_b32 v202, 32, v200
  v_xor_b32 v203, 160, v200
  v_xor_b32 v204, 64, v200
  v_xor_b32 v205, 192, v200
  v_mul_f32 v88, v88, v217
  v_mul_f32 v89, v89, v217
  v_cvt_pk_bf16_f32 v44, v88, v89
  s_waitcnt lgkmcnt(8)
  v_mfma_f32_16x16x32_bf16 v[164:167], a[240:243], a[112:115], v[164:167]
  v_xor_b32 v206, 96, v200
  v_xor_b32 v207, 224, v200
  v_add_u32 v208, s39, v211
  v_mfma_f32_32x32x16_bf16 v[144:159], a[208:211], a[32:35], v[144:159]
  s_waitcnt vmcnt(24) lgkmcnt(0)
  s_barrier
  ds_read_b64_tr_b16 a[176:177], v200 offset:0
  ds_read_b64_tr_b16 a[178:179], v201 offset:2048
  ds_read_b64_tr_b16 a[180:181], v200 offset:4096
  ds_read_b64_tr_b16 a[182:183], v201 offset:6144
  v_mul_f32 v90, v90, v217
  v_mul_f32 v91, v91, v217
  v_cvt_pk_bf16_f32 v45, v90, v91
  v_mul_f32 v92, v92, v217
  v_mul_f32 v93, v93, v217
  v_mfma_f32_32x32x16_bf16 v[144:159], a[212:215], a[36:39], v[144:159]
  ds_read_b64_tr_b16 a[184:185], v200 offset:8192
  ds_read_b64_tr_b16 a[186:187], v201 offset:10240
  ds_read_b64_tr_b16 a[188:189], v200 offset:12288
  ds_read_b64_tr_b16 a[190:191], v201 offset:14336
  v_cvt_pk_bf16_f32 v46, v92, v93
  v_mul_f32 v94, v94, v217
  s_add_u32 s43, s54, 368896
  v_mfma_f32_32x32x16_bf16 v[144:159], a[216:219], a[40:43], v[144:159]
  ds_read_b128 a[120:123], v227 offset:6144
  ds_read_b64_tr_b16 a[224:225], v208 offset:0
  ds_read_b64_tr_b16 a[226:227], v208 offset:1024
  v_mul_f32 v95, v95, v217
  v_cvt_pk_bf16_f32 v47, v94, v95
  s_cmp_ge_u32 s54, 1024
  v_mfma_f32_32x32x16_bf16 v[144:159], a[220:223], a[44:47], v[144:159]
  ds_read_b64_tr_b16 a[192:193], v200 offset:16384
  ds_read_b64_tr_b16 a[194:195], v201 offset:18432
  s_cselect_b32 s43, 0x10000000, s43
  s_waitcnt lgkmcnt(11)
  v_mfma_f32_16x16x32_bf16 v[164:167], a[244:247], a[116:119], v[164:167]
  ds_read_b64_tr_b16 a[196:197], v200 offset:20480
  ds_read_b64_tr_b16 a[198:199], v201 offset:22528
  v_mfma_f32_32x32x16_bf16 v[96:111], a[176:179], v[0:3], v[96:111]
  ds_read_b64_tr_b16 a[200:201], v202 offset:0
  ds_read_b64_tr_b16 a[202:203], v203 offset:2048
  s_add_u32 m0, s42, 0
  s_waitcnt lgkmcnt(11)
  v_mfma_f32_32x32x16_bf16 v[96:111], a[180:183], v[4:7], v[96:111]
  ds_read_b64_tr_b16 a[204:205], v202 offset:4096
  ds_read_b64_tr_b16 a[206:207], v203 offset:6144
  buffer_load_dwordx4 v192, s[20:23], s43 offen offset:0 lds
  v_mfma_f32_32x32x16_bf16 v[96:111], a[184:187], v[8:11], v[96:111]
  ds_read_b128 a[124:127], v244 offset:6144
  ds_read_b64_tr_b16 a[228:229], v208 offset:8192
  ds_read_b64_tr_b16 a[230:231], v208 offset:9216
  s_waitcnt lgkmcnt(11)
  v_mfma_f32_32x32x16_bf16 v[96:111], a[188:191], v[12:15], v[96:111]
  ds_read_b64_tr_b16 a[208:209], v202 offset:8192
  ds_read_b64_tr_b16 a[210:211], v203 offset:10240
  s_waitcnt lgkmcnt(11)
  v_mfma_f32_16x16x32_bf16 v[160:163], a[224:227], a[120:123], v[160:163]
  ds_read_b64_tr_b16 a[212:213], v202 offset:12288
  ds_read_b64_tr_b16 a[214:215], v203 offset:14336
  v_mfma_f32_32x32x16_bf16 v[96:111], a[192:195], v[16:19], v[96:111]
  ds_read_b64_tr_b16 a[216:217], v202 offset:16384
  ds_read_b64_tr_b16 a[218:219], v203 offset:18432
  buffer_load_dwordx4 v193, s[20:23], s43 offen offset:1024 lds
  s_waitcnt lgkmcnt(11)
  v_mfma_f32_32x32x16_bf16 v[96:111], a[196:199], v[20:23], v[96:111]
  ds_read_b64_tr_b16 a[220:221], v202 offset:20480
  ds_read_b64_tr_b16 a[222:223], v203 offset:22528
  buffer_load_dwordx4 v194, s[20:23], s43 offen offset:2048 lds
  v_mfma_f32_32x32x16_bf16 v[112:127], a[200:203], v[0:3], v[112:127]
  ds_read_b128 a[128:131], v227 offset:6272
  ds_read_b64_tr_b16 a[232:233], v208 offset:16384
  ds_read_b64_tr_b16 a[234:235], v208 offset:17408
  s_waitcnt lgkmcnt(11)
  v_mfma_f32_32x32x16_bf16 v[112:127], a[204:207], v[4:7], v[112:127]
  ds_read_b64_tr_b16 a[176:177], v204 offset:0
  ds_read_b64_tr_b16 a[178:179], v205 offset:2048
  s_waitcnt lgkmcnt(11)
  v_mfma_f32_16x16x32_bf16 v[160:163], a[228:231], a[124:127], v[160:163]
  ds_read_b64_tr_b16 a[180:181], v204 offset:4096
  ds_read_b64_tr_b16 a[182:183], v205 offset:6144
  v_mfma_f32_32x32x16_bf16 v[112:127], a[208:211], v[8:11], v[112:127]
  ds_read_b64_tr_b16 a[184:185], v204 offset:8192
  ds_read_b64_tr_b16 a[186:187], v205 offset:10240
  s_add_u32 m0, s42, 3072
  s_waitcnt lgkmcnt(11)
  v_mfma_f32_32x32x16_bf16 v[112:127], a[212:215], v[12:15], v[112:127]
  ds_read_b64_tr_b16 a[188:189], v204 offset:12288
  ds_read_b64_tr_b16 a[190:191], v205 offset:14336
  buffer_load_dwordx4 v195, s[20:23], s43 offen offset:0 lds
  v_mfma_f32_32x32x16_bf16 v[112:127], a[216:219], v[16:19], v[112:127]
  ds_read_b64_tr_b16 a[236:237], v208 offset:8
  ds_read_b64_tr_b16 a[238:239], v208 offset:1032
  s_waitcnt lgkmcnt(10)
  v_mfma_f32_32x32x16_bf16 v[112:127], a[220:223], v[20:23], v[112:127]
  ds_read_b64_tr_b16 a[192:193], v204 offset:16384
  ds_read_b64_tr_b16 a[194:195], v205 offset:18432
  s_waitcnt lgkmcnt(10)
  v_mfma_f32_16x16x32_bf16 v[160:163], a[232:235], a[128:131], v[160:163]
  ds_read_b64_tr_b16 a[196:197], v204 offset:20480
  ds_read_b64_tr_b16 a[198:199], v205 offset:22528
  v_mfma_f32_32x32x16_bf16 v[128:143], a[176:179], v[0:3], v[128:143]
  ds_read_b64_tr_b16 a[200:201], v206 offset:0
  ds_read_b64_tr_b16 a[202:203], v207 offset:2048
  buffer_load_dwordx4 v196, s[20:23], s43 offen offset:1024 lds
  s_waitcnt lgkmcnt(10)
  v_mfma_f32_32x32x16_bf16 v[128:143], a[180:183], v[4:7], v[128:143]
  ds_read_b64_tr_b16 a[204:205], v206 offset:4096
  ds_read_b64_tr_b16 a[206:207], v207 offset:6144
  buffer_load_dwordx4 v197, s[20:23], s43 offen offset:2048 lds
  v_mfma_f32_32x32x16_bf16 v[128:143], a[184:187], v[8:11], v[128:143]
  ds_read_b64_tr_b16 a[240:241], v208 offset:8200
  ds_read_b64_tr_b16 a[242:243], v208 offset:9224
  s_waitcnt lgkmcnt(10)
  v_mfma_f32_32x32x16_bf16 v[128:143], a[188:191], v[12:15], v[128:143]
  ds_read_b64_tr_b16 a[208:209], v206 offset:8192
  ds_read_b64_tr_b16 a[210:211], v207 offset:10240
  s_waitcnt lgkmcnt(10)
  v_mfma_f32_16x16x32_bf16 v[164:167], a[236:239], a[120:123], v[164:167]
  ds_read_b64_tr_b16 a[212:213], v206 offset:12288
  ds_read_b64_tr_b16 a[214:215], v207 offset:14336
  v_mfma_f32_32x32x16_bf16 v[128:143], a[192:195], v[16:19], v[128:143]
  ds_read_b64_tr_b16 a[216:217], v206 offset:16384
  ds_read_b64_tr_b16 a[218:219], v207 offset:18432
  s_waitcnt lgkmcnt(10)
  v_mfma_f32_32x32x16_bf16 v[128:143], a[196:199], v[20:23], v[128:143]
  ds_read_b64_tr_b16 a[220:221], v206 offset:20480
  ds_read_b64_tr_b16 a[222:223], v207 offset:22528
  s_add_u32 s42, s39, s37
  s_add_u32 s39, s39, 24576
  s_cmp_eq_u32 s39, 147456
  v_mfma_f32_32x32x16_bf16 v[144:159], a[200:203], v[0:3], v[144:159]
  ds_read_b64_tr_b16 a[244:245], v208 offset:16392
  ds_read_b64_tr_b16 a[246:247], v208 offset:17416
  s_cselect_b32 s39, 0, s39
  v_add_u32 v228, s39, v210
  s_waitcnt lgkmcnt(10)
  v_mfma_f32_32x32x16_bf16 v[144:159], a[204:207], v[4:7], v[144:159]
  v_xor_b32 v229, 128, v228
  v_xor_b32 v230, 32, v228
  v_xor_b32 v231, 160, v228
  v_xor_b32 v232, 64, v228
  v_xor_b32 v233, 192, v228
  s_waitcnt lgkmcnt(8)
  v_mfma_f32_16x16x32_bf16 v[164:167], a[240:243], a[124:127], v[164:167]
  v_xor_b32 v234, 96, v228
  v_xor_b32 v235, 224, v228
  v_add_u32 v236, s39, v211
  v_mfma_f32_32x32x16_bf16 v[144:159], a[208:211], v[8:11], v[144:159]
  s_waitcnt vmcnt(24) lgkmcnt(0)
  s_barrier
  ds_read_b64_tr_b16 a[176:177], v228 offset:0
  ds_read_b64_tr_b16 a[178:179], v229 offset:2048
  ds_read_b64_tr_b16 a[180:181], v228 offset:4096
  ds_read_b64_tr_b16 a[182:183], v229 offset:6144
  v_mfma_f32_32x32x16_bf16 v[144:159], a[212:215], v[12:15], v[144:159]
  ds_read_b64_tr_b16 a[184:185], v228 offset:8192
  ds_read_b64_tr_b16 a[186:187], v229 offset:10240
  ds_read_b64_tr_b16 a[188:189], v228 offset:12288
  ds_read_b64_tr_b16 a[190:191], v229 offset:14336
  s_add_u32 s43, s54, 512
  v_mfma_f32_32x32x16_bf16 v[144:159], a[216:219], v[16:19], v[144:159]
  ds_read_b128 a[132:135], v244 offset:6272
  ds_read_b64_tr_b16 a[224:225], v236 offset:0
  ds_read_b64_tr_b16 a[226:227], v236 offset:1024
  s_cmp_ge_u32 s54, 768
  v_mfma_f32_32x32x16_bf16 v[144:159], a[220:223], v[20:23], v[144:159]
  ds_read_b64_tr_b16 a[192:193], v228 offset:16384
  ds_read_b64_tr_b16 a[194:195], v229 offset:18432
  s_cselect_b32 s43, 0x10000000, s43
  s_waitcnt lgkmcnt(11)
  v_mfma_f32_16x16x32_bf16 v[164:167], a[244:247], a[128:131], v[164:167]
  ds_read_b64_tr_b16 a[196:197], v228 offset:20480
  ds_read_b64_tr_b16 a[198:199], v229 offset:22528
  v_mfma_f32_32x32x16_bf16 v[96:111], a[176:179], v[24:27], v[96:111]
  ds_read_b64_tr_b16 a[200:201], v230 offset:0
  ds_read_b64_tr_b16 a[202:203], v231 offset:2048
  s_add_u32 m0, s42, 0
  s_waitcnt lgkmcnt(11)
  v_mfma_f32_32x32x16_bf16 v[96:111], a[180:183], v[28:31], v[96:111]
  ds_read_b64_tr_b16 a[204:205], v230 offset:4096
  ds_read_b64_tr_b16 a[206:207], v231 offset:6144
  buffer_load_dwordx4 v192, s[20:23], s43 offen offset:0 lds
  v_mfma_f32_32x32x16_bf16 v[96:111], a[184:187], v[32:35], v[96:111]
  ds_read_b128 a[136:139], v227 offset:6400
  ds_read_b64_tr_b16 a[228:229], v236 offset:8192
  ds_read_b64_tr_b16 a[230:231], v236 offset:9216
  s_waitcnt lgkmcnt(11)
  v_mfma_f32_32x32x16_bf16 v[96:111], a[188:191], v[36:39], v[96:111]
  ds_read_b64_tr_b16 a[208:209], v230 offset:8192
  ds_read_b64_tr_b16 a[210:211], v231 offset:10240
  s_waitcnt lgkmcnt(11)
  v_mfma_f32_16x16x32_bf16 v[160:163], a[224:227], a[132:135], v[160:163]
  ds_read_b64_tr_b16 a[212:213], v230 offset:12288
  ds_read_b64_tr_b16 a[214:215], v231 offset:14336
  v_mfma_f32_32x32x16_bf16 v[96:111], a[192:195], v[40:43], v[96:111]
  ds_read_b64_tr_b16 a[216:217], v230 offset:16384
  ds_read_b64_tr_b16 a[218:219], v231 offset:18432
  buffer_load_dwordx4 v193, s[20:23], s43 offen offset:1024 lds
  s_waitcnt lgkmcnt(11)
  v_mfma_f32_32x32x16_bf16 v[96:111], a[196:199], v[44:47], v[96:111]
  ds_read_b64_tr_b16 a[220:221], v230 offset:20480
  ds_read_b64_tr_b16 a[222:223], v231 offset:22528
  buffer_load_dwordx4 v194, s[20:23], s43 offen offset:2048 lds
  v_mfma_f32_32x32x16_bf16 v[112:127], a[200:203], v[24:27], v[112:127]
  ds_read_b128 a[140:143], v244 offset:6400
  ds_read_b64_tr_b16 a[232:233], v236 offset:16384
  ds_read_b64_tr_b16 a[234:235], v236 offset:17408
  s_waitcnt lgkmcnt(11)
  v_mfma_f32_32x32x16_bf16 v[112:127], a[204:207], v[28:31], v[112:127]
  ds_read_b64_tr_b16 a[176:177], v232 offset:0
  ds_read_b64_tr_b16 a[178:179], v233 offset:2048
  s_nop 0
  v_cvt_pk_bf16_f32 v168, v96, v97
  v_cvt_pk_bf16_f32 v169, v98, v99
  s_waitcnt lgkmcnt(11)
  v_mfma_f32_16x16x32_bf16 v[160:163], a[228:231], a[136:139], v[160:163]
  ds_read_b64_tr_b16 a[180:181], v232 offset:4096
  ds_read_b64_tr_b16 a[182:183], v233 offset:6144
  s_add_u32 m0, s42, 3072
  v_cvt_pk_bf16_f32 v170, v100, v101
  v_cvt_pk_bf16_f32 v171, v102, v103
  v_mfma_f32_32x32x16_bf16 v[112:127], a[208:211], v[32:35], v[112:127]
  ds_read_b64_tr_b16 a[184:185], v232 offset:8192
  ds_read_b64_tr_b16 a[186:187], v233 offset:10240
  v_cvt_pk_bf16_f32 v172, v104, v105
  v_cvt_pk_bf16_f32 v173, v106, v107
  s_waitcnt lgkmcnt(11)
  v_mfma_f32_32x32x16_bf16 v[112:127], a[212:215], v[36:39], v[112:127]
  ds_read_b64_tr_b16 a[188:189], v232 offset:12288
  ds_read_b64_tr_b16 a[190:191], v233 offset:14336
  buffer_load_dwordx4 v195, s[20:23], s43 offen offset:0 lds
  v_cvt_pk_bf16_f32 v174, v108, v109
  v_cvt_pk_bf16_f32 v175, v110, v111
  v_mfma_f32_32x32x16_bf16 v[112:127], a[216:219], v[40:43], v[112:127]
  ds_read_b64_tr_b16 a[236:237], v236 offset:8
  ds_read_b64_tr_b16 a[238:239], v236 offset:1032
  buffer_store_dwordx4 v[168:171], v248, s[24:27], s55 offen offset:0 sc1
  buffer_store_dwordx4 v[172:175], v248, s[24:27], s55 offen offset:1024 sc1
  s_waitcnt lgkmcnt(10)
  v_mfma_f32_32x32x16_bf16 v[112:127], a[220:223], v[44:47], v[112:127]
  ds_read_b64_tr_b16 a[192:193], v232 offset:16384
  ds_read_b64_tr_b16 a[194:195], v233 offset:18432
  s_waitcnt lgkmcnt(10)
  v_mfma_f32_16x16x32_bf16 v[160:163], a[232:235], a[140:143], v[160:163]
  ds_read_b64_tr_b16 a[196:197], v232 offset:20480
  ds_read_b64_tr_b16 a[198:199], v233 offset:22528
  v_mfma_f32_32x32x16_bf16 v[128:143], a[176:179], v[24:27], v[128:143]
  ds_read_b64_tr_b16 a[200:201], v234 offset:0
  ds_read_b64_tr_b16 a[202:203], v235 offset:2048
  buffer_load_dwordx4 v196, s[20:23], s43 offen offset:1024 lds
  s_waitcnt lgkmcnt(10)
  v_mfma_f32_32x32x16_bf16 v[128:143], a[180:183], v[28:31], v[128:143]
  ds_read_b64_tr_b16 a[204:205], v234 offset:4096
  ds_read_b64_tr_b16 a[206:207], v235 offset:6144
  buffer_load_dwordx4 v197, s[20:23], s43 offen offset:2048 lds
  v_cvt_pk_bf16_f32 v176, v112, v113
  v_cvt_pk_bf16_f32 v177, v114, v115
  v_cvt_pk_bf16_f32 v178, v116, v117
  v_mfma_f32_32x32x16_bf16 v[128:143], a[184:187], v[32:35], v[128:143]
  ds_read_b64_tr_b16 a[240:241], v236 offset:8200
  ds_read_b64_tr_b16 a[242:243], v236 offset:9224
  v_cvt_pk_bf16_f32 v179, v118, v119
  v_cvt_pk_bf16_f32 v180, v120, v121
  s_waitcnt lgkmcnt(10)
  v_mfma_f32_32x32x16_bf16 v[128:143], a[188:191], v[36:39], v[128:143]
  ds_read_b64_tr_b16 a[208:209], v234 offset:8192
  ds_read_b64_tr_b16 a[210:211], v235 offset:10240
  v_cvt_pk_bf16_f32 v181, v122, v123
  v_cvt_pk_bf16_f32 v182, v124, v125
  s_add_u32 s54, s54, 256
  s_waitcnt lgkmcnt(10)
  v_mfma_f32_16x16x32_bf16 v[164:167], a[236:239], a[132:135], v[164:167]
  ds_read_b64_tr_b16 a[212:213], v234 offset:12288
  ds_read_b64_tr_b16 a[214:215], v235 offset:14336
  v_mfma_f32_32x32x16_bf16 v[128:143], a[192:195], v[40:43], v[128:143]
  ds_read_b64_tr_b16 a[216:217], v234 offset:16384
  ds_read_b64_tr_b16 a[218:219], v235 offset:18432
  v_cvt_pk_bf16_f32 v183, v126, v127
  buffer_store_dwordx4 v[176:179], v248, s[24:27], s55 offen offset:2048 sc1
  buffer_store_dwordx4 v[180:183], v248, s[24:27], s55 offen offset:3072 sc1
  s_add_u32 s55, s55, 4096
  s_waitcnt lgkmcnt(10)
  v_mfma_f32_32x32x16_bf16 v[128:143], a[196:199], v[44:47], v[128:143]
LO:
  ds_read_b64_tr_b16 a[220:221], v234 offset:20480
  ds_read_b64_tr_b16 a[222:223], v235 offset:22528
  s_add_u32 s42, s39, s37
  s_add_u32 s39, s39, 24576
  v_mfma_f32_32x32x16_bf16 v[144:159], a[200:203], v[24:27], v[144:159]
  ds_read_b64_tr_b16 a[244:245], v236 offset:16392
  ds_read_b64_tr_b16 a[246:247], v236 offset:17416
  s_cmp_eq_u32 s39, 147456
  s_cselect_b32 s39, 0, s39
  v_add_u32 v200, s39, v210
  v_xor_b32 v201, 128, v200
  s_waitcnt lgkmcnt(10)
  v_mfma_f32_32x32x16_bf16 v[144:159], a[204:207], v[28:31], v[144:159]
  v_xor_b32 v202, 32, v200
  v_xor_b32 v203, 160, v200
  v_xor_b32 v204, 64, v200
  v_xor_b32 v205, 192, v200
  v_cvt_pk_bf16_f32 v168, v128, v129
  v_cvt_pk_bf16_f32 v169, v130, v131
  s_waitcnt lgkmcnt(8)
  v_mfma_f32_16x16x32_bf16 v[164:167], a[240:243], a[136:139], v[164:167]
  v_xor_b32 v206, 96, v200
  v_xor_b32 v207, 224, v200
  v_add_u32 v208, s39, v211
  v_mfma_f32_32x32x16_bf16 v[144:159], a[208:211], v[32:35], v[144:159]
  s_waitcnt vmcnt(28) lgkmcnt(0)
  s_barrier
  ds_read_b64_tr_b16 a[176:177], v200 offset:0
  ds_read_b64_tr_b16 a[178:179], v201 offset:2048
  ds_read_b64_tr_b16 a[180:181], v200 offset:4096
  ds_read_b64_tr_b16 a[182:183], v201 offset:6144
  v_cvt_pk_bf16_f32 v170, v132, v133
  v_cvt_pk_bf16_f32 v171, v134, v135
  v_cvt_pk_bf16_f32 v172, v136, v137
  v_cvt_pk_bf16_f32 v173, v138, v139
  v_mfma_f32_32x32x16_bf16 v[144:159], a[212:215], v[36:39], v[144:159]
  ds_read_b64_tr_b16 a[184:185], v200 offset:8192
  ds_read_b64_tr_b16 a[186:187], v201 offset:10240
  ds_read_b64_tr_b16 a[188:189], v200 offset:12288
  ds_read_b64_tr_b16 a[190:191], v201 offset:14336
  v_cvt_pk_bf16_f32 v174, v140, v141
  v_cvt_pk_bf16_f32 v175, v142, v143
  s_add_u32 s43, s54, 123136
  v_mfma_f32_32x32x16_bf16 v[144:159], a[216:219], v[40:43], v[144:159]
  ds_read_b64_tr_b16 a[224:225], v208 offset:0
  ds_read_b64_tr_b16 a[226:227], v208 offset:1024
  buffer_store_dwordx4 v[168:171], v248, s[24:27], s55 offen offset:0 sc1
  buffer_store_dwordx4 v[172:175], v248, s[24:27], s55 offen offset:1024 sc1
  s_cmp_ge_u32 s54, 1024
  v_mfma_f32_32x32x16_bf16 v[144:159], a[220:223], v[44:47], v[144:159]
  ds_read_b64_tr_b16 a[192:193], v200 offset:16384
  ds_read_b64_tr_b16 a[194:195], v201 offset:18432
  s_cselect_b32 s43, 0x10000000, s43
  s_waitcnt lgkmcnt(10)
  v_mfma_f32_16x16x32_bf16 v[164:167], a[244:247], a[140:143], v[164:167]
  ds_read_b64_tr_b16 a[196:197], v200 offset:20480
  ds_read_b64_tr_b16 a[198:199], v201 offset:22528
  v_mfma_f32_32x32x16_bf16 v[96:111], a[176:179], a[0:3], 0
  ds_read_b64_tr_b16 a[200:201], v202 offset:0
  ds_read_b64_tr_b16 a[202:203], v203 offset:2048
  s_add_u32 m0, s42, 0
  v_cvt_pk_bf16_f32 v184, v160, v161
  v_cvt_pk_bf16_f32 v185, v162, v163
  s_waitcnt lgkmcnt(10)
  v_mfma_f32_32x32x16_bf16 v[96:111], a[180:183], a[4:7], v[96:111]
  ds_read_b64_tr_b16 a[204:205], v202 offset:4096
  ds_read_b64_tr_b16 a[206:207], v203 offset:6144
  buffer_load_dwordx4 v192, s[20:23], s43 offen offset:0 lds
  v_cvt_pk_bf16_f32 v186, v164, v165
  v_mfma_f32_32x32x16_bf16 v[96:111], a[184:187], a[8:11], v[96:111]
  ds_read_b64_tr_b16 a[228:229], v208 offset:8192
  ds_read_b64_tr_b16 a[230:231], v208 offset:9216
  v_cvt_pk_bf16_f32 v187, v166, v167
  s_waitcnt lgkmcnt(10)
  v_mfma_f32_32x32x16_bf16 v[96:111], a[188:191], a[12:15], v[96:111]
  ds_read_b64_tr_b16 a[208:209], v202 offset:8192
  ds_read_b64_tr_b16 a[210:211], v203 offset:10240
  v_cvt_pk_bf16_f32 v176, v144, v145
  v_cvt_pk_bf16_f32 v177, v146, v147
  s_waitcnt lgkmcnt(10)
  v_mfma_f32_16x16x32_bf16 v[160:163], a[224:227], a[96:99], 0
  ds_read_b64_tr_b16 a[212:213], v202 offset:12288
  ds_read_b64_tr_b16 a[214:215], v203 offset:14336
  v_mfma_f32_32x32x16_bf16 v[96:111], a[192:195], a[16:19], v[96:111]
  ds_read_b64_tr_b16 a[216:217], v202 offset:16384
  ds_read_b64_tr_b16 a[218:219], v203 offset:18432
  buffer_load_dwordx4 v193, s[20:23], s43 offen offset:1024 lds
  v_cvt_pk_bf16_f32 v178, v148, v149
  v_cvt_pk_bf16_f32 v179, v150, v151
  v_cvt_pk_bf16_f32 v180, v152, v153
  s_waitcnt lgkmcnt(10)
  v_mfma_f32_32x32x16_bf16 v[96:111], a[196:199], a[20:23], v[96:111]
  ds_read_b64_tr_b16 a[220:221], v202 offset:20480
  ds_read_b64_tr_b16 a[222:223], v203 offset:22528
  buffer_load_dwordx4 v194, s[20:23], s43 offen offset:2048 lds
  v_cvt_pk_bf16_f32 v181, v154, v155
  v_mfma_f32_32x32x16_bf16 v[112:127], a[200:203], a[0:3], 0
  ds_read_b64_tr_b16 a[232:233], v208 offset:16384
  ds_read_b64_tr_b16 a[234:235], v208 offset:17408
  v_cvt_pk_bf16_f32 v182, v156, v157
  v_cvt_pk_bf16_f32 v183, v158, v159
  s_waitcnt lgkmcnt(10)
  v_mfma_f32_32x32x16_bf16 v[112:127], a[204:207], a[4:7], v[112:127]
  ds_read_b64_tr_b16 a[176:177], v204 offset:0
  ds_read_b64_tr_b16 a[178:179], v205 offset:2048
  buffer_store_dwordx4 v[176:179], v248, s[24:27], s55 offen offset:2048 sc1
  s_waitcnt lgkmcnt(10)
  v_mfma_f32_16x16x32_bf16 v[160:163], a[228:231], a[100:103], v[160:163]
  ds_read_b64_tr_b16 a[180:181], v204 offset:4096
  ds_read_b64_tr_b16 a[182:183], v205 offset:6144
  s_add_u32 m0, s42, 3072
  buffer_store_dwordx4 v[180:183], v248, s[24:27], s55 offen offset:3072 sc1
  buffer_store_dwordx4 v[184:187], v249, s[24:27], s55 offen sc1
  v_mfma_f32_32x32x16_bf16 v[112:127], a[208:211], a[8:11], v[112:127]
  ds_read_b64_tr_b16 a[184:185], v204 offset:8192
  ds_read_b64_tr_b16 a[186:187], v205 offset:10240
  s_add_u32 s55, s55, 32768
  s_waitcnt lgkmcnt(10)
  v_mfma_f32_32x32x16_bf16 v[112:127], a[212:215], a[12:15], v[112:127]
  ds_read_b64_tr_b16 a[188:189], v204 offset:12288
  ds_read_b64_tr_b16 a[190:191], v205 offset:14336
  buffer_load_dwordx4 v195, s[20:23], s43 offen offset:0 lds
  v_mfma_f32_32x32x16_bf16 v[112:127], a[216:219], a[16:19], v[112:127]
  ds_read_b64_tr_b16 a[236:237], v208 offset:8
  ds_read_b64_tr_b16 a[238:239], v208 offset:1032
  s_waitcnt lgkmcnt(10)
  v_mfma_f32_32x32x16_bf16 v[112:127], a[220:223], a[20:23], v[112:127]
  ds_read_b64_tr_b16 a[192:193], v204 offset:16384
  ds_read_b64_tr_b16 a[194:195], v205 offset:18432
  s_waitcnt lgkmcnt(10)
  v_mfma_f32_16x16x32_bf16 v[160:163], a[232:235], a[104:107], v[160:163]
  ds_read_b64_tr_b16 a[196:197], v204 offset:20480
  ds_read_b64_tr_b16 a[198:199], v205 offset:22528
  v_mfma_f32_32x32x16_bf16 v[128:143], a[176:179], a[0:3], 0
  ds_read_b64_tr_b16 a[200:201], v206 offset:0
  ds_read_b64_tr_b16 a[202:203], v207 offset:2048
  buffer_load_dwordx4 v196, s[20:23], s43 offen offset:1024 lds
  s_waitcnt lgkmcnt(10)
  v_mfma_f32_32x32x16_bf16 v[128:143], a[180:183], a[4:7], v[128:143]
  ds_read_b64_tr_b16 a[204:205], v206 offset:4096
  ds_read_b64_tr_b16 a[206:207], v207 offset:6144
  buffer_load_dwordx4 v197, s[20:23], s43 offen offset:2048 lds
  v_mfma_f32_32x32x16_bf16 v[128:143], a[184:187], a[8:11], v[128:143]
  ds_read_b64_tr_b16 a[240:241], v208 offset:8200
  ds_read_b64_tr_b16 a[242:243], v208 offset:9224
  s_waitcnt lgkmcnt(10)
  v_mfma_f32_32x32x16_bf16 v[128:143], a[188:191], a[12:15], v[128:143]
  ds_read_b64_tr_b16 a[208:209], v206 offset:8192
  ds_read_b64_tr_b16 a[210:211], v207 offset:10240
  s_waitcnt lgkmcnt(10)
  v_mfma_f32_16x16x32_bf16 v[164:167], a[236:239], a[96:99], 0
  ds_read_b64_tr_b16 a[212:213], v206 offset:12288
  ds_read_b64_tr_b16 a[214:215], v207 offset:14336
  v_mfma_f32_32x32x16_bf16 v[128:143], a[192:195], a[16:19], v[128:143]
  ds_read_b64_tr_b16 a[216:217], v206 offset:16384
  ds_read_b64_tr_b16 a[218:219], v207 offset:18432
  s_waitcnt lgkmcnt(10)
  v_mfma_f32_32x32x16_bf16 v[128:143], a[196:199], a[20:23], v[128:143]
  ds_read_b64_tr_b16 a[220:221], v206 offset:20480
  ds_read_b64_tr_b16 a[222:223], v207 offset:22528
  s_add_u32 s42, s39, s37
  s_add_u32 s39, s39, 24576
  s_cmp_eq_u32 s39, 147456
  v_mfma_f32_32x32x16_bf16 v[144:159], a[200:203], a[0:3], 0
  ds_read_b64_tr_b16 a[244:245], v208 offset:16392
  ds_read_b64_tr_b16 a[246:247], v208 offset:17416
  s_cselect_b32 s39, 0, s39
  v_add_u32 v228, s39, v210
  s_waitcnt lgkmcnt(10)
  v_mfma_f32_32x32x16_bf16 v[144:159], a[204:207], a[4:7], v[144:159]
  v_xor_b32 v229, 128, v228
  v_xor_b32 v230, 32, v228
  v_xor_b32 v231, 160, v228
  v_xor_b32 v232, 64, v228
  v_xor_b32 v233, 192, v228
  s_waitcnt lgkmcnt(8)
  v_mfma_f32_16x16x32_bf16 v[164:167], a[240:243], a[100:103], v[164:167]
  v_xor_b32 v234, 96, v228
  v_xor_b32 v235, 224, v228
  v_add_u32 v236, s39, v211
  v_mfma_f32_32x32x16_bf16 v[144:159], a[208:211], a[8:11], v[144:159]
  s_waitcnt vmcnt(33) lgkmcnt(0)
  s_barrier
  ds_read_b64_tr_b16 a[176:177], v228 offset:0
  ds_read_b64_tr_b16 a[178:179], v229 offset:2048
  ds_read_b64_tr_b16 a[180:181], v228 offset:4096
  ds_read_b64_tr_b16 a[182:183], v229 offset:6144
  v_mfma_f32_32x32x16_bf16 v[144:159], a[212:215], a[12:15], v[144:159]
  ds_read_b64_tr_b16 a[184:185], v228 offset:8192
  ds_read_b64_tr_b16 a[186:187], v229 offset:10240
  ds_read_b64_tr_b16 a[188:189], v228 offset:12288
  ds_read_b64_tr_b16 a[190:191], v229 offset:14336
  s_add_u32 s43, s54, 246016
  v_mfma_f32_32x32x16_bf16 v[144:159], a[216:219], a[16:19], v[144:159]
  ds_read_b64_tr_b16 a[224:225], v236 offset:0
  ds_read_b64_tr_b16 a[226:227], v236 offset:1024
  s_cmp_ge_u32 s54, 1024
  v_mfma_f32_32x32x16_bf16 v[144:159], a[220:223], a[20:23], v[144:159]
  ds_read_b64_tr_b16 a[192:193], v228 offset:16384
  ds_read_b64_tr_b16 a[194:195], v229 offset:18432
  s_cselect_b32 s43, 0x10000000, s43
  s_waitcnt lgkmcnt(10)
  v_mfma_f32_16x16x32_bf16 v[164:167], a[244:247], a[104:107], v[164:167]
  ds_read_b64_tr_b16 a[196:197], v228 offset:20480
  ds_read_b64_tr_b16 a[198:199], v229 offset:22528
  v_mfma_f32_32x32x16_bf16 v[96:111], a[176:179], a[24:27], v[96:111]
  ds_read_b64_tr_b16 a[200:201], v230 offset:0
  ds_read_b64_tr_b16 a[202:203], v231 offset:2048
  s_add_u32 m0, s42, 0
  s_waitcnt lgkmcnt(10)
  v_mfma_f32_32x32x16_bf16 v[96:111], a[180:183], a[28:31], v[96:111]
  ds_read_b64_tr_b16 a[204:205], v230 offset:4096
  ds_read_b64_tr_b16 a[206:207], v231 offset:6144
  buffer_load_dwordx4 v192, s[20:23], s43 offen offset:0 lds
  v_mfma_f32_32x32x16_bf16 v[96:111], a[184:187], a[32:35], v[96:111]
  ds_read_b64_tr_b16 a[228:229], v236 offset:8192
  ds_read_b64_tr_b16 a[230:231], v236 offset:9216
  s_waitcnt lgkmcnt(10)
  v_mfma_f32_32x32x16_bf16 v[96:111], a[188:191], a[36:39], v[96:111]
  ds_read_b64_tr_b16 a[208:209], v230 offset:8192
  ds_read_b64_tr_b16 a[210:211], v231 offset:10240
  s_waitcnt lgkmcnt(10)
  v_mfma_f32_16x16x32_bf16 v[160:163], a[224:227], a[108:111], v[160:163]
  ds_read_b64_tr_b16 a[212:213], v230 offset:12288
  ds_read_b64_tr_b16 a[214:215], v231 offset:14336
  v_mfma_f32_32x32x16_bf16 v[96:111], a[192:195], a[40:43], v[96:111]
  ds_read_b64_tr_b16 a[216:217], v230 offset:16384
  ds_read_b64_tr_b16 a[218:219], v231 offset:18432
  buffer_load_dwordx4 v193, s[20:23], s43 offen offset:1024 lds
  s_waitcnt lgkmcnt(10)
  v_mfma_f32_32x32x16_bf16 v[96:111], a[196:199], a[44:47], v[96:111]
  ds_read_b64_tr_b16 a[220:221], v230 offset:20480
  ds_read_b64_tr_b16 a[222:223], v231 offset:22528
  buffer_load_dwordx4 v194, s[20:23], s43 offen offset:2048 lds
  v_mfma_f32_32x32x16_bf16 v[112:127], a[200:203], a[24:27], v[112:127]
  ds_read_b64_tr_b16 a[232:233], v236 offset:16384
  ds_read_b64_tr_b16 a[234:235], v236 offset:17408
  s_waitcnt lgkmcnt(10)
  v_mfma_f32_32x32x16_bf16 v[112:127], a[204:207], a[28:31], v[112:127]
  ds_read_b64_tr_b16 a[176:177], v232 offset:0
  ds_read_b64_tr_b16 a[178:179], v233 offset:2048
  s_waitcnt lgkmcnt(10)
  v_mfma_f32_16x16x32_bf16 v[160:163], a[228:231], a[112:115], v[160:163]
  ds_read_b64_tr_b16 a[180:181], v232 offset:4096
  ds_read_b64_tr_b16 a[182:183], v233 offset:6144
  v_mfma_f32_32x32x16_bf16 v[112:127], a[208:211], a[32:35], v[112:127]
  ds_read_b64_tr_b16 a[184:185], v232 offset:8192
  ds_read_b64_tr_b16 a[186:187], v233 offset:10240
  s_add_u32 m0, s42, 3072
  s_waitcnt lgkmcnt(10)
  v_mfma_f32_32x32x16_bf16 v[112:127], a[212:215], a[36:39], v[112:127]
  ds_read_b64_tr_b16 a[188:189], v232 offset:12288
  ds_read_b64_tr_b16 a[190:191], v233 offset:14336
  buffer_load_dwordx4 v195, s[20:23], s43 offen offset:0 lds
  v_mfma_f32_32x32x16_bf16 v[112:127], a[216:219], a[40:43], v[112:127]
  ds_read_b64_tr_b16 a[236:237], v236 offset:8
  ds_read_b64_tr_b16 a[238:239], v236 offset:1032
  s_waitcnt lgkmcnt(10)
  v_mfma_f32_32x32x16_bf16 v[112:127], a[220:223], a[44:47], v[112:127]
  ds_read_b64_tr_b16 a[192:193], v232 offset:16384
  ds_read_b64_tr_b16 a[194:195], v233 offset:18432
  s_waitcnt lgkmcnt(10)
  v_mfma_f32_16x16x32_bf16 v[160:163], a[232:235], a[116:119], v[160:163]
  ds_read_b64_tr_b16 a[196:197], v232 offset:20480
  ds_read_b64_tr_b16 a[198:199], v233 offset:22528
  v_mfma_f32_32x32x16_bf16 v[128:143], a[176:179], a[24:27], v[128:143]
  ds_read_b64_tr_b16 a[200:201], v234 offset:0
  ds_read_b64_tr_b16 a[202:203], v235 offset:2048
  buffer_load_dwordx4 v196, s[20:23], s43 offen offset:1024 lds
  s_waitcnt lgkmcnt(10)
  v_mfma_f32_32x32x16_bf16 v[128:143], a[180:183], a[28:31], v[128:143]
  ds_read_b64_tr_b16 a[204:205], v234 offset:4096
  ds_read_b64_tr_b16 a[206:207], v235 offset:6144
  buffer_load_dwordx4 v197, s[20:23], s43 offen offset:2048 lds
  v_mfma_f32_32x32x16_bf16 v[128:143], a[184:187], a[32:35], v[128:143]
  ds_read_b64_tr_b16 a[240:241], v236 offset:8200
  ds_read_b64_tr_b16 a[242:243], v236 offset:9224
  s_waitcnt lgkmcnt(10)
  v_mfma_f32_32x32x16_bf16 v[128:143], a[188:191], a[36:39], v[128:143]
  ds_read_b64_tr_b16 a[208:209], v234 offset:8192
  ds_read_b64_tr_b16 a[210:211], v235 offset:10240
  s_waitcnt lgkmcnt(10)
  v_mfma_f32_16x16x32_bf16 v[164:167], a[236:239], a[108:111], v[164:167]
  ds_read_b64_tr_b16 a[212:213], v234 offset:12288
  ds_read_b64_tr_b16 a[214:215], v235 offset:14336
  v_mfma_f32_32x32x16_bf16 v[128:143], a[192:195], a[40:43], v[128:143]
  ds_read_b64_tr_b16 a[216:217], v234 offset:16384
  ds_read_b64_tr_b16 a[218:219], v235 offset:18432
  s_waitcnt lgkmcnt(10)
  v_mfma_f32_32x32x16_bf16 v[128:143], a[196:199], a[44:47], v[128:143]
  ds_read_b64_tr_b16 a[220:221], v234 offset:20480
  ds_read_b64_tr_b16 a[222:223], v235 offset:22528
  s_add_u32 s42, s39, s37
  s_add_u32 s39, s39, 24576
  s_cmp_eq_u32 s39, 147456
  v_mfma_f32_32x32x16_bf16 v[144:159], a[200:203], a[24:27], v[144:159]
  ds_read_b64_tr_b16 a[244:245], v236 offset:16392
  ds_read_b64_tr_b16 a[246:247], v236 offset:17416
  s_cselect_b32 s39, 0, s39
  v_add_u32 v200, s39, v210
  s_waitcnt lgkmcnt(10)
  v_mfma_f32_32x32x16_bf16 v[144:159], a[204:207], a[28:31], v[144:159]
  v_xor_b32 v201, 128, v200
  v_xor_b32 v202, 32, v200
  v_xor_b32 v203, 160, v200
  v_xor_b32 v204, 64, v200
  v_xor_b32 v205, 192, v200
  s_waitcnt lgkmcnt(8)
  v_mfma_f32_16x16x32_bf16 v[164:167], a[240:243], a[112:115], v[164:167]
  v_xor_b32 v206, 96, v200
  v_xor_b32 v207, 224, v200
  v_add_u32 v208, s39, v211
  v_mfma_f32_32x32x16_bf16 v[144:159], a[208:211], a[32:35], v[144:159]
  s_waitcnt vmcnt(33) lgkmcnt(0)
  s_barrier
  ds_read_b64_tr_b16 a[176:177], v200 offset:0
  ds_read_b64_tr_b16 a[178:179], v201 offset:2048
  ds_read_b64_tr_b16 a[180:181], v200 offset:4096
  ds_read_b64_tr_b16 a[182:183], v201 offset:6144
  v_mfma_f32_32x32x16_bf16 v[144:159], a[212:215], a[36:39], v[144:159]
  ds_read_b64_tr_b16 a[184:185], v200 offset:8192
  ds_read_b64_tr_b16 a[186:187], v201 offset:10240
  ds_read_b64_tr_b16 a[188:189], v200 offset:12288
  ds_read_b64_tr_b16 a[190:191], v201 offset:14336
  s_add_u32 s43, s54, 368896
  v_mfma_f32_32x32x16_bf16 v[144:159], a[216:219], a[40:43], v[144:159]
  ds_read_b64_tr_b16 a[224:225], v208 offset:0
  ds_read_b64_tr_b16 a[226:227], v208 offset:1024
  s_cmp_ge_u32 s54, 1024
  v_mfma_f32_32x32x16_bf16 v[144:159], a[220:223], a[44:47], v[144:159]
  ds_read_b64_tr_b16 a[192:193], v200 offset:16384
  ds_read_b64_tr_b16 a[194:195], v201 offset:18432
  s_cselect_b32 s43, 0x10000000, s43
  s_waitcnt lgkmcnt(10)
  v_mfma_f32_16x16x32_bf16 v[164:167], a[244:247], a[116:119], v[164:167]
  ds_read_b64_tr_b16 a[196:197], v200 offset:20480
  ds_read_b64_tr_b16 a[198:199], v201 offset:22528
  v_mfma_f32_32x32x16_bf16 v[96:111], a[176:179], v[0:3], v[96:111]
  ds_read_b64_tr_b16 a[200:201], v202 offset:0
  ds_read_b64_tr_b16 a[202:203], v203 offset:2048
  s_add_u32 m0, s42, 0
  s_waitcnt lgkmcnt(10)
  v_mfma_f32_32x32x16_bf16 v[96:111], a[180:183], v[4:7], v[96:111]
  ds_read_b64_tr_b16 a[204:205], v202 offset:4096
  ds_read_b64_tr_b16 a[206:207], v203 offset:6144
  buffer_load_dwordx4 v192, s[20:23], s43 offen offset:0 lds
  v_mfma_f32_32x32x16_bf16 v[96:111], a[184:187], v[8:11], v[96:111]
  ds_read_b64_tr_b16 a[228:229], v208 offset:8192
  ds_read_b64_tr_b16 a[230:231], v208 offset:9216
  s_waitcnt lgkmcnt(10)
  v_mfma_f32_32x32x16_bf16 v[96:111], a[188:191], v[12:15], v[96:111]
  ds_read_b64_tr_b16 a[208:209], v202 offset:8192
  ds_read_b64_tr_b16 a[210:211], v203 offset:10240
  s_waitcnt lgkmcnt(10)
  v_mfma_f32_16x16x32_bf16 v[160:163], a[224:227], a[120:123], v[160:163]
  ds_read_b64_tr_b16 a[212:213], v202 offset:12288
  ds_read_b64_tr_b16 a[214:215], v203 offset:14336
  v_mfma_f32_32x32x16_bf16 v[96:111], a[192:195], v[16:19], v[96:111]
  ds_read_b64_tr_b16 a[216:217], v202 offset:16384
  ds_read_b64_tr_b16 a[218:219], v203 offset:18432
  buffer_load_dwordx4 v193, s[20:23], s43 offen offset:1024 lds
  s_waitcnt lgkmcnt(10)
  v_mfma_f32_32x32x16_bf16 v[96:111], a[196:199], v[20:23], v[96:111]
  ds_read_b64_tr_b16 a[220:221], v202 offset:20480
  ds_read_b64_tr_b16 a[222:223], v203 offset:22528
  buffer_load_dwordx4 v194, s[20:23], s43 offen offset:2048 lds
  v_mfma_f32_32x32x16_bf16 v[112:127], a[200:203], v[0:3], v[112:127]
  ds_read_b64_tr_b16 a[232:233], v208 offset:16384
  ds_read_b64_tr_b16 a[234:235], v208 offset:17408
  s_waitcnt lgkmcnt(10)
  v_mfma_f32_32x32x16_bf16 v[112:127], a[204:207], v[4:7], v[112:127]
  ds_read_b64_tr_b16 a[176:177], v204 offset:0
  ds_read_b64_tr_b16 a[178:179], v205 offset:2048
  s_waitcnt lgkmcnt(10)
  v_mfma_f32_16x16x32_bf16 v[160:163], a[228:231], a[124:127], v[160:163]
  ds_read_b64_tr_b16 a[180:181], v204 offset:4096
  ds_read_b64_tr_b16 a[182:183], v205 offset:6144
  v_mfma_f32_32x32x16_bf16 v[112:127], a[208:211], v[8:11], v[112:127]
  ds_read_b64_tr_b16 a[184:185], v204 offset:8192
  ds_read_b64_tr_b16 a[186:187], v205 offset:10240
  s_add_u32 m0, s42, 3072
  s_waitcnt lgkmcnt(10)
  v_mfma_f32_32x32x16_bf16 v[112:127], a[212:215], v[12:15], v[112:127]
  ds_read_b64_tr_b16 a[188:189], v204 offset:12288
  ds_read_b64_tr_b16 a[190:191], v205 offset:14336
  buffer_load_dwordx4 v195, s[20:23], s43 offen offset:0 lds
  v_mfma_f32_32x32x16_bf16 v[112:127], a[216:219], v[16:19], v[112:127]
  ds_read_b64_tr_b16 a[236:237], v208 offset:8
  ds_read_b64_tr_b16 a[238:239], v208 offset:1032
  s_waitcnt lgkmcnt(10)
  v_mfma_f32_32x32x16_bf16 v[112:127], a[220:223], v[20:23], v[112:127]
  ds_read_b64_tr_b16 a[192:193], v204 offset:16384
  ds_read_b64_tr_b16 a[194:195], v205 offset:18432
  s_waitcnt lgkmcnt(10)
  v_mfma_f32_16x16x32_bf16 v[160:163], a[232:235], a[128:131], v[160:163]
  ds_read_b64_tr_b16 a[196:197], v204 offset:20480
  ds_read_b64_tr_b16 a[198:199], v205 offset:22528
  v_mfma_f32_32x32x16_bf16 v[128:143], a[176:179], v[0:3], v[128:143]
  ds_read_b64_tr_b16 a[200:201], v206 offset:0
  ds_read_b64_tr_b16 a[202:203], v207 offset:2048
  buffer_load_dwordx4 v196, s[20:23], s43 offen offset:1024 lds
  s_waitcnt lgkmcnt(10)
  v_mfma_f32_32x32x16_bf16 v[128:143], a[180:183], v[4:7], v[128:143]
  ds_read_b64_tr_b16 a[204:205], v206 offset:4096
  ds_read_b64_tr_b16 a[206:207], v207 offset:6144
  buffer_load_dwordx4 v197, s[20:23], s43 offen offset:2048 lds
  v_mfma_f32_32x32x16_bf16 v[128:143], a[184:187], v[8:11], v[128:143]
  ds_read_b64_tr_b16 a[240:241], v208 offset:8200
  ds_read_b64_tr_b16 a[242:243], v208 offset:9224
  s_waitcnt lgkmcnt(10)
  v_mfma_f32_32x32x16_bf16 v[128:143], a[188:191], v[12:15], v[128:143]
  ds_read_b64_tr_b16 a[208:209], v206 offset:8192
  ds_read_b64_tr_b16 a[210:211], v207 offset:10240
  s_waitcnt lgkmcnt(10)
  v_mfma_f32_16x16x32_bf16 v[164:167], a[236:239], a[120:123], v[164:167]
  ds_read_b64_tr_b16 a[212:213], v206 offset:12288
  ds_read_b64_tr_b16 a[214:215], v207 offset:14336
  v_mfma_f32_32x32x16_bf16 v[128:143], a[192:195], v[16:19], v[128:143]
  ds_read_b64_tr_b16 a[216:217], v206 offset:16384
  ds_read_b64_tr_b16 a[218:219], v207 offset:18432
  s_waitcnt lgkmcnt(10)
  v_mfma_f32_32x32x16_bf16 v[128:143], a[196:199], v[20:23], v[128:143]
  ds_read_b64_tr_b16 a[220:221], v206 offset:20480
  ds_read_b64_tr_b16 a[222:223], v207 offset:22528
  s_add_u32 s42, s39, s37
  s_add_u32 s39, s39, 24576
  s_cmp_eq_u32 s39, 147456
  v_mfma_f32_32x32x16_bf16 v[144:159], a[200:203], v[0:3], v[144:159]
  ds_read_b64_tr_b16 a[244:245], v208 offset:16392
  ds_read_b64_tr_b16 a[246:247], v208 offset:17416
  s_cselect_b32 s39, 0, s39
  v_add_u32 v228, s39, v210
  s_waitcnt lgkmcnt(10)
  v_mfma_f32_32x32x16_bf16 v[144:159], a[204:207], v[4:7], v[144:159]
  v_xor_b32 v229, 128, v228
  v_xor_b32 v230, 32, v228
  v_xor_b32 v231, 160, v228
  v_xor_b32 v232, 64, v228
  v_xor_b32 v233, 192, v228
  s_waitcnt lgkmcnt(8)
  v_mfma_f32_16x16x32_bf16 v[164:167], a[240:243], a[124:127], v[164:167]
  v_xor_b32 v234, 96, v228
  v_xor_b32 v235, 224, v228
  v_add_u32 v236, s39, v211
  v_mfma_f32_32x32x16_bf16 v[144:159], a[208:211], v[8:11], v[144:159]
  s_waitcnt vmcnt(33) lgkmcnt(0)
  s_barrier
  ds_read_b64_tr_b16 a[176:177], v228 offset:0
  ds_read_b64_tr_b16 a[178:179], v229 offset:2048
  ds_read_b64_tr_b16 a[180:181], v228 offset:4096
  ds_read_b64_tr_b16 a[182:183], v229 offset:6144
  v_mfma_f32_32x32x16_bf16 v[144:159], a[212:215], v[12:15], v[144:159]
  ds_read_b64_tr_b16 a[184:185], v228 offset:8192
  ds_read_b64_tr_b16 a[186:187], v229 offset:10240
  ds_read_b64_tr_b16 a[188:189], v228 offset:12288
  ds_read_b64_tr_b16 a[190:191], v229 offset:14336
  s_add_u32 s43, s54, 512
  v_mfma_f32_32x32x16_bf16 v[144:159], a[216:219], v[16:19], v[144:159]
  ds_read_b64_tr_b16 a[224:225], v236 offset:0
  ds_read_b64_tr_b16 a[226:227], v236 offset:1024
  s_cmp_ge_u32 s54, 768
  v_mfma_f32_32x32x16_bf16 v[144:159], a[220:223], v[20:23], v[144:159]
  ds_read_b64_tr_b16 a[192:193], v228 offset:16384
  ds_read_b64_tr_b16 a[194:195], v229 offset:18432
  s_cselect_b32 s43, 0x10000000, s43
  s_waitcnt lgkmcnt(10)
  v_mfma_f32_16x16x32_bf16 v[164:167], a[244:247], a[128:131], v[164:167]
  ds_read_b64_tr_b16 a[196:197], v228 offset:20480
  ds_read_b64_tr_b16 a[198:199], v229 offset:22528
  v_mfma_f32_32x32x16_bf16 v[96:111], a[176:179], v[24:27], v[96:111]
  ds_read_b64_tr_b16 a[200:201], v230 offset:0
  ds_read_b64_tr_b16 a[202:203], v231 offset:2048
  s_add_u32 m0, s42, 0
  s_waitcnt lgkmcnt(10)
  v_mfma_f32_32x32x16_bf16 v[96:111], a[180:183], v[28:31], v[96:111]
  ds_read_b64_tr_b16 a[204:205], v230 offset:4096
  ds_read_b64_tr_b16 a[206:207], v231 offset:6144
  buffer_load_dwordx4 v192, s[20:23], s43 offen offset:0 lds
  v_mfma_f32_32x32x16_bf16 v[96:111], a[184:187], v[32:35], v[96:111]
  ds_read_b64_tr_b16 a[228:229], v236 offset:8192
  ds_read_b64_tr_b16 a[230:231], v236 offset:9216
  s_waitcnt lgkmcnt(10)
  v_mfma_f32_32x32x16_bf16 v[96:111], a[188:191], v[36:39], v[96:111]
  ds_read_b64_tr_b16 a[208:209], v230 offset:8192
  ds_read_b64_tr_b16 a[210:211], v231 offset:10240
  s_waitcnt lgkmcnt(10)
  v_mfma_f32_16x16x32_bf16 v[160:163], a[224:227], a[132:135], v[160:163]
  ds_read_b64_tr_b16 a[212:213], v230 offset:12288
  ds_read_b64_tr_b16 a[214:215], v231 offset:14336
  v_mfma_f32_32x32x16_bf16 v[96:111], a[192:195], v[40:43], v[96:111]
  ds_read_b64_tr_b16 a[216:217], v230 offset:16384
  ds_read_b64_tr_b16 a[218:219], v231 offset:18432
  buffer_load_dwordx4 v193, s[20:23], s43 offen offset:1024 lds
  s_waitcnt lgkmcnt(10)
  v_mfma_f32_32x32x16_bf16 v[96:111], a[196:199], v[44:47], v[96:111]
  ds_read_b64_tr_b16 a[220:221], v230 offset:20480
  ds_read_b64_tr_b16 a[222:223], v231 offset:22528
  buffer_load_dwordx4 v194, s[20:23], s43 offen offset:2048 lds
  v_mfma_f32_32x32x16_bf16 v[112:127], a[200:203], v[24:27], v[112:127]
  ds_read_b64_tr_b16 a[232:233], v236 offset:16384
  ds_read_b64_tr_b16 a[234:235], v236 offset:17408
  s_waitcnt lgkmcnt(10)
  v_mfma_f32_32x32x16_bf16 v[112:127], a[204:207], v[28:31], v[112:127]
  ds_read_b64_tr_b16 a[176:177], v232 offset:0
  ds_read_b64_tr_b16 a[178:179], v233 offset:2048
  s_nop 1
  v_cvt_pk_bf16_f32 v168, v96, v97
  v_cvt_pk_bf16_f32 v169, v98, v99
  s_waitcnt lgkmcnt(10)
  v_mfma_f32_16x16x32_bf16 v[160:163], a[228:231], a[136:139], v[160:163]
  ds_read_b64_tr_b16 a[180:181], v232 offset:4096
  ds_read_b64_tr_b16 a[182:183], v233 offset:6144
  s_add_u32 m0, s42, 3072
  v_cvt_pk_bf16_f32 v170, v100, v101
  v_cvt_pk_bf16_f32 v171, v102, v103
  v_mfma_f32_32x32x16_bf16 v[112:127], a[208:211], v[32:35], v[112:127]
  ds_read_b64_tr_b16 a[184:185], v232 offset:8192
  ds_read_b64_tr_b16 a[186:187], v233 offset:10240
  v_cvt_pk_bf16_f32 v172, v104, v105
  v_cvt_pk_bf16_f32 v173, v106, v107
  s_waitcnt lgkmcnt(10)
  v_mfma_f32_32x32x16_bf16 v[112:127], a[212:215], v[36:39], v[112:127]
  ds_read_b64_tr_b16 a[188:189], v232 offset:12288
  ds_read_b64_tr_b16 a[190:191], v233 offset:14336
  buffer_load_dwordx4 v195, s[20:23], s43 offen offset:0 lds
  v_cvt_pk_bf16_f32 v174, v108, v109
  v_cvt_pk_bf16_f32 v175, v110, v111
  v_mfma_f32_32x32x16_bf16 v[112:127], a[216:219], v[40:43], v[112:127]
  ds_read_b64_tr_b16 a[236:237], v236 offset:8
  ds_read_b64_tr_b16 a[238:239], v236 offset:1032
  buffer_store_dwordx4 v[168:171], v248, s[24:27], s55 offen offset:0 sc1
  buffer_store_dwordx4 v[172:175], v248, s[24:27], s55 offen offset:1024 sc1
  s_waitcnt lgkmcnt(10)
  v_mfma_f32_32x32x16_bf16 v[112:127], a[220:223], v[44:47], v[112:127]
  ds_read_b64_tr_b16 a[192:193], v232 offset:16384
  ds_read_b64_tr_b16 a[194:195], v233 offset:18432
  s_waitcnt lgkmcnt(10)
  v_mfma_f32_16x16x32_bf16 v[160:163], a[232:235], a[140:143], v[160:163]
  ds_read_b64_tr_b16 a[196:197], v232 offset:20480
  ds_read_b64_tr_b16 a[198:199], v233 offset:22528
  v_mfma_f32_32x32x16_bf16 v[128:143], a[176:179], v[24:27], v[128:143]
  ds_read_b64_tr_b16 a[200:201], v234 offset:0
  ds_read_b64_tr_b16 a[202:203], v235 offset:2048
  buffer_load_dwordx4 v196, s[20:23], s43 offen offset:1024 lds
  s_waitcnt lgkmcnt(10)
  v_mfma_f32_32x32x16_bf16 v[128:143], a[180:183], v[28:31], v[128:143]
  ds_read_b64_tr_b16 a[204:205], v234 offset:4096
  ds_read_b64_tr_b16 a[206:207], v235 offset:6144
  buffer_load_dwordx4 v197, s[20:23], s43 offen offset:2048 lds
  v_cvt_pk_bf16_f32 v176, v112, v113
  v_cvt_pk_bf16_f32 v177, v114, v115
  v_cvt_pk_bf16_f32 v178, v116, v117
  v_mfma_f32_32x32x16_bf16 v[128:143], a[184:187], v[32:35], v[128:143]
  ds_read_b64_tr_b16 a[240:241], v236 offset:8200
  ds_read_b64_tr_b16 a[242:243], v236 offset:9224
  v_cvt_pk_bf16_f32 v179, v118, v119
  v_cvt_pk_bf16_f32 v180, v120, v121
  s_waitcnt lgkmcnt(10)
  v_mfma_f32_32x32x16_bf16 v[128:143], a[188:191], v[36:39], v[128:143]
  ds_read_b64_tr_b16 a[208:209], v234 offset:8192
  ds_read_b64_tr_b16 a[210:211], v235 offset:10240
  v_cvt_pk_bf16_f32 v181, v122, v123
  v_cvt_pk_bf16_f32 v182, v124, v125
  s_add_u32 s54, s54, 256
  s_waitcnt lgkmcnt(10)
  v_mfma_f32_16x16x32_bf16 v[164:167], a[236:239], a[132:135], v[164:167]
  ds_read_b64_tr_b16 a[212:213], v234 offset:12288
  ds_read_b64_tr_b16 a[214:215], v235 offset:14336
  v_mfma_f32_32x32x16_bf16 v[128:143], a[192:195], v[40:43], v[128:143]
  ds_read_b64_tr_b16 a[216:217], v234 offset:16384
  ds_read_b64_tr_b16 a[218:219], v235 offset:18432
  v_cvt_pk_bf16_f32 v183, v126, v127
  buffer_store_dwordx4 v[176:179], v248, s[24:27], s55 offen offset:2048 sc1
  buffer_store_dwordx4 v[180:183], v248, s[24:27], s55 offen offset:3072 sc1
  s_add_u32 s55, s55, 4096
  s_waitcnt lgkmcnt(10)
  v_mfma_f32_32x32x16_bf16 v[128:143], a[196:199], v[44:47], v[128:143]
  s_cmp_lg_u32 s54, 1280
  s_cbranch_scc1 LO
  ds_read_b64_tr_b16 a[220:221], v234 offset:20480
  ds_read_b64_tr_b16 a[222:223], v235 offset:22528
  v_mfma_f32_32x32x16_bf16 v[144:159], a[200:203], v[24:27], v[144:159]
  ds_read_b64_tr_b16 a[244:245], v236 offset:16392
  ds_read_b64_tr_b16 a[246:247], v236 offset:17416
  s_waitcnt lgkmcnt(10)
  v_mfma_f32_32x32x16_bf16 v[144:159], a[204:207], v[28:31], v[144:159]
  s_nop 2
  v_cvt_pk_bf16_f32 v168, v128, v129
  v_cvt_pk_bf16_f32 v169, v130, v131
  s_waitcnt lgkmcnt(8)
  v_mfma_f32_16x16x32_bf16 v[164:167], a[240:243], a[136:139], v[164:167]
  v_mfma_f32_32x32x16_bf16 v[144:159], a[208:211], v[32:35], v[144:159]
  v_cvt_pk_bf16_f32 v170, v132, v133
  v_cvt_pk_bf16_f32 v171, v134, v135
  v_cvt_pk_bf16_f32 v172, v136, v137
  v_cvt_pk_bf16_f32 v173, v138, v139
  s_waitcnt lgkmcnt(4)
  v_mfma_f32_32x32x16_bf16 v[144:159], a[212:215], v[36:39], v[144:159]
  v_cvt_pk_bf16_f32 v174, v140, v141
  v_cvt_pk_bf16_f32 v175, v142, v143
  v_mfma_f32_32x32x16_bf16 v[144:159], a[216:219], v[40:43], v[144:159]
  buffer_store_dwordx4 v[168:171], v248, s[24:27], s55 offen offset:0 sc1
  buffer_store_dwordx4 v[172:175], v248, s[24:27], s55 offen offset:1024 sc1
  s_waitcnt lgkmcnt(0)
  v_mfma_f32_32x32x16_bf16 v[144:159], a[220:223], v[44:47], v[144:159]
  v_mfma_f32_16x16x32_bf16 v[164:167], a[244:247], a[140:143], v[164:167]
  s_nop 7
  s_nop 2
  v_cvt_pk_bf16_f32 v176, v144, v145
  v_cvt_pk_bf16_f32 v177, v146, v147
  v_cvt_pk_bf16_f32 v178, v148, v149
  v_cvt_pk_bf16_f32 v179, v150, v151
  v_cvt_pk_bf16_f32 v180, v152, v153
  v_cvt_pk_bf16_f32 v181, v154, v155
  v_cvt_pk_bf16_f32 v182, v156, v157
  v_cvt_pk_bf16_f32 v183, v158, v159
  buffer_store_dwordx4 v[176:179], v248, s[24:27], s55 offen offset:2048 sc1
  buffer_store_dwordx4 v[180:183], v248, s[24:27], s55 offen offset:3072 sc1
  v_cvt_pk_bf16_f32 v184, v160, v161
  v_cvt_pk_bf16_f32 v185, v162, v163
  v_cvt_pk_bf16_f32 v186, v164, v165
  v_cvt_pk_bf16_f32 v187, v166, v167
  buffer_store_dwordx4 v[184:187], v249, s[24:27], s55 offen sc1
  s_add_u32 s55, s55, 32768
  s_waitcnt vmcnt(0)
K1END:
  s_endpgm
RARE0:
  s_nop 7
  s_nop 7
  v_mul_f32 v0, v0, v217
  v_mul_f32 v1, v1, v217
  v_mul_f32 v2, v2, v217
  v_mul_f32 v3, v3, v217
  v_mul_f32 v4, v4, v217
  v_mul_f32 v5, v5, v217
  v_mul_f32 v6, v6, v217
  v_mul_f32 v7, v7, v217
  v_mul_f32 v8, v8, v217
  v_mul_f32 v9, v9, v217
  v_mul_f32 v10, v10, v217
  v_mul_f32 v11, v11, v217
  v_mul_f32 v12, v12, v217
  v_mul_f32 v13, v13, v217
  v_mul_f32 v14, v14, v217
  v_mul_f32 v15, v15, v217
  v_mul_f32 v16, v16, v217
  v_mul_f32 v17, v17, v217
  v_mul_f32 v18, v18, v217
  v_mul_f32 v19, v19, v217
  v_mul_f32 v20, v20, v217
  v_mul_f32 v21, v21, v217
  v_mul_f32 v22, v22, v217
  v_mul_f32 v23, v23, v217
  v_mul_f32 v24, v24, v217
  v_mul_f32 v25, v25, v217
  v_mul_f32 v26, v26, v217
  v_mul_f32 v27, v27, v217
  v_mul_f32 v28, v28, v217
  v_mul_f32 v29, v29, v217
  v_mul_f32 v30, v30, v217
  v_mul_f32 v31, v31, v217
  v_mul_f32 v32, v32, v217
  v_mul_f32 v33, v33, v217
  v_mul_f32 v34, v34, v217
  v_mul_f32 v35, v35, v217
  v_mul_f32 v36, v36, v217
  v_mul_f32 v37, v37, v217
  v_mul_f32 v38, v38, v217
  v_mul_f32 v39, v39, v217
  v_mul_f32 v40, v40, v217
  v_mul_f32 v41, v41, v217
  v_mul_f32 v42, v42, v217
  v_mul_f32 v43, v43, v217
  v_mul_f32 v44, v44, v217
  v_mul_f32 v45, v45, v217
  v_mul_f32 v46, v46, v217
  v_mul_f32 v47, v47, v217
  v_mul_f32 v48, v48, v217
  v_mul_f32 v49, v49, v217
  v_mul_f32 v50, v50, v217
  v_mul_f32 v51, v51, v217
  v_mul_f32 v52, v52, v217
  v_mul_f32 v53, v53, v217
  v_mul_f32 v54, v54, v217
  v_mul_f32 v55, v55, v217
  v_mul_f32 v56, v56, v217
  v_mul_f32 v57, v57, v217
  v_mul_f32 v58, v58, v217
  v_mul_f32 v59, v59, v217
  v_mul_f32 v60, v60, v217
  v_mul_f32 v61, v61, v217
  v_mul_f32 v62, v62, v217
  v_mul_f32 v63, v63, v217
  v_mul_f32 v64, v64, v217
  v_mul_f32 v65, v65, v217
  v_mul_f32 v66, v66, v217
  v_mul_f32 v67, v67, v217
  v_mul_f32 v68, v68, v217
  v_mul_f32 v69, v69, v217
  v_mul_f32 v70, v70, v217
  v_mul_f32 v71, v71, v217
  v_mul_f32 v72, v72, v217
  v_mul_f32 v73, v73, v217
  v_mul_f32 v74, v74, v217
  v_mul_f32 v75, v75, v217
  v_mul_f32 v76, v76, v217
  v_mul_f32 v77, v77, v217
  v_mul_f32 v78, v78, v217
  v_mul_f32 v79, v79, v217
  v_mul_f32 v80, v80, v217
  v_mul_f32 v81, v81, v217
  v_mul_f32 v82, v82, v217
  v_mul_f32 v83, v83, v217
  v_mul_f32 v84, v84, v217
  v_mul_f32 v85, v85, v217
  v_mul_f32 v86, v86, v217
  v_mul_f32 v87, v87, v217
  v_mul_f32 v88, v88, v217
  v_mul_f32 v89, v89, v217
  v_mul_f32 v90, v90, v217
  v_mul_f32 v91, v91, v217
  v_mul_f32 v92, v92, v217
  v_mul_f32 v93, v93, v217
  v_mul_f32 v94, v94, v217
  v_mul_f32 v95, v95, v217
  s_nop 1
  s_branch RET0
RARE0_7:
  s_nop 7
  s_nop 7
  v_mul_f32 v0, v0, v217
  v_mul_f32 v1, v1, v217
  v_mul_f32 v2, v2, v217
  v_mul_f32 v3, v3, v217
  v_mul_f32 v4, v4, v217
  v_mul_f32 v5, v5, v217
  v_mul_f32 v6, v6, v217
  v_mul_f32 v7, v7, v217
  v_mul_f32 v8, v8, v217
  v_mul_f32 v9, v9, v217
  v_mul_f32 v10, v10, v217
  v_mul_f32 v11, v11, v217
  v_mul_f32 v12, v12, v217
  v_mul_f32 v13, v13, v217
  v_mul_f32 v14, v14, v217
  v_mul_f32 v15, v15, v217
  v_mul_f32 v16, v16, v217
  v_mul_f32 v17, v17, v217
  v_mul_f32 v18, v18, v217
  v_mul_f32 v19, v19, v217
  v_mul_f32 v20, v20, v217
  v_mul_f32 v21, v21, v217
  v_mul_f32 v22, v22, v217
  v_mul_f32 v23, v23, v217
  v_mul_f32 v24, v24, v217
  v_mul_f32 v25, v25, v217
  v_mul_f32 v26, v26, v217
  v_mul_f32 v27, v27, v217
  v_mul_f32 v28, v28, v217
  v_mul_f32 v29, v29, v217
  v_mul_f32 v30, v30, v217
  v_mul_f32 v31, v31, v217
  v_mul_f32 v32, v32, v217
  v_mul_f32 v33, v33, v217
  v_mul_f32 v34, v34, v217
  v_mul_f32 v35, v35, v217
  v_mul_f32 v36, v36, v217
  v_mul_f32 v37, v37, v217
  v_mul_f32 v38, v38, v217
  v_mul_f32 v39, v39, v217
  v_mul_f32 v40, v40, v217
  v_mul_f32 v41, v41, v217
  v_mul_f32 v42, v42, v217
  v_mul_f32 v43, v43, v217
  v_mul_f32 v44, v44, v217
  v_mul_f32 v45, v45, v217
  v_mul_f32 v46, v46, v217
  v_mul_f32 v47, v47, v217
  v_mul_f32 v48, v48, v217
  v_mul_f32 v49, v49, v217
  v_mul_f32 v50, v50, v217
  v_mul_f32 v51, v51, v217
  v_mul_f32 v52, v52, v217
  v_mul_f32 v53, v53, v217
  v_mul_f32 v54, v54, v217
  v_mul_f32 v55, v55, v217
  v_mul_f32 v56, v56, v217
  v_mul_f32 v57, v57, v217
  v_mul_f32 v58, v58, v217
  v_mul_f32 v59, v59, v217
  v_mul_f32 v60, v60, v217
  v_mul_f32 v61, v61, v217
  v_mul_f32 v62, v62, v217
  v_mul_f32 v63, v63, v217
  v_mul_f32 v64, v64, v217
  v_mul_f32 v65, v65, v217
  v_mul_f32 v66, v66, v217
  v_mul_f32 v67, v67, v217
  v_mul_f32 v68, v68, v217
  v_mul_f32 v69, v69, v217
  v_mul_f32 v70, v70, v217
  v_mul_f32 v71, v71, v217
  v_mul_f32 v72, v72, v217
  v_mul_f32 v73, v73, v217
  v_mul_f32 v74, v74, v217
  v_mul_f32 v75, v75, v217
  v_mul_f32 v76, v76, v217
  v_mul_f32 v77, v77, v217
  v_mul_f32 v78, v78, v217
  v_mul_f32 v79, v79, v217
  v_mul_f32 v80, v80, v217
  v_mul_f32 v81, v81, v217
  v_mul_f32 v82, v82, v217
  v_mul_f32 v83, v83, v217
  v_mul_f32 v84, v84, v217
  v_mul_f32 v85, v85, v217
  v_mul_f32 v86, v86, v217
  v_mul_f32 v87, v87, v217
  v_mul_f32 v88, v88, v217
  v_mul_f32 v89, v89, v217
  v_mul_f32 v90, v90, v217
  v_mul_f32 v91, v91, v217
  v_mul_f32 v92, v92, v217
  v_mul_f32 v93, v93, v217
  v_mul_f32 v94, v94, v217
  v_mul_f32 v95, v95, v217
  s_nop 1
  s_branch RET0_7
RARE1:
  s_nop 7
  s_nop 7
  v_mul_f32 v0, v0, v217
  v_mul_f32 v1, v1, v217
  v_mul_f32 v2, v2, v217
  v_mul_f32 v3, v3, v217
  v_mul_f32 v4, v4, v217
  v_mul_f32 v5, v5, v217
  v_mul_f32 v6, v6, v217
  v_mul_f32 v7, v7, v217
  v_mul_f32 v8, v8, v217
  v_mul_f32 v9, v9, v217
  v_mul_f32 v10, v10, v217
  v_mul_f32 v11, v11, v217
  v_mul_f32 v12, v12, v217
  v_mul_f32 v13, v13, v217
  v_mul_f32 v14, v14, v217
  v_mul_f32 v15, v15, v217
  v_mul_f32 v16, v16, v217
  v_mul_f32 v17, v17, v217
  v_mul_f32 v18, v18, v217
  v_mul_f32 v19, v19, v217
  v_mul_f32 v20, v20, v217
  v_mul_f32 v21, v21, v217
  v_mul_f32 v22, v22, v217
  v_mul_f32 v23, v23, v217
  v_mul_f32 v24, v24, v217
  v_mul_f32 v25, v25, v217
  v_mul_f32 v26, v26, v217
  v_mul_f32 v27, v27, v217
  v_mul_f32 v28, v28, v217
  v_mul_f32 v29, v29, v217
  v_mul_f32 v30, v30, v217
  v_mul_f32 v31, v31, v217
  v_mul_f32 v32, v32, v217
  v_mul_f32 v33, v33, v217
  v_mul_f32 v34, v34, v217
  v_mul_f32 v35, v35, v217
  v_mul_f32 v36, v36, v217
  v_mul_f32 v37, v37, v217
  v_mul_f32 v38, v38, v217
  v_mul_f32 v39, v39, v217
  v_mul_f32 v40, v40, v217
  v_mul_f32 v41, v41, v217
  v_mul_f32 v42, v42, v217
  v_mul_f32 v43, v43, v217
  v_mul_f32 v44, v44, v217
  v_mul_f32 v45, v45, v217
  v_mul_f32 v46, v46, v217
  v_mul_f32 v47, v47, v217
  v_mul_f32 v48, v48, v217
  v_mul_f32 v49, v49, v217
  v_mul_f32 v50, v50, v217
  v_mul_f32 v51, v51, v217
  v_mul_f32 v52, v52, v217
  v_mul_f32 v53, v53, v217
  v_mul_f32 v54, v54, v217
  v_mul_f32 v55, v55, v217
  v_mul_f32 v56, v56, v217
  v_mul_f32 v57, v57, v217
  v_mul_f32 v58, v58, v217
  v_mul_f32 v59, v59, v217
  v_mul_f32 v60, v60, v217
  v_mul_f32 v61, v61, v217
  v_mul_f32 v62, v62, v217
  v_mul_f32 v63, v63, v217
  v_mul_f32 v64, v64, v217
  v_mul_f32 v65, v65, v217
  v_mul_f32 v66, v66, v217
  v_mul_f32 v67, v67, v217
  v_mul_f32 v68, v68, v217
  v_mul_f32 v69, v69, v217
  v_mul_f32 v70, v70, v217
  v_mul_f32 v71, v71, v217
  v_mul_f32 v72, v72, v217
  v_mul_f32 v73, v73, v217
  v_mul_f32 v74, v74, v217
  v_mul_f32 v75, v75, v217
  v_mul_f32 v76, v76, v217
  v_mul_f32 v77, v77, v217
  v_mul_f32 v78, v78, v217
  v_mul_f32 v79, v79, v217
  v_mul_f32 v80, v80, v217
  v_mul_f32 v81, v81, v217
  v_mul_f32 v82, v82, v217
  v_mul_f32 v83, v83, v217
  v_mul_f32 v84, v84, v217
  v_mul_f32 v85, v85, v217
  v_mul_f32 v86, v86, v217
  v_mul_f32 v87, v87, v217
  v_mul_f32 v88, v88, v217
  v_mul_f32 v89, v89, v217
  v_mul_f32 v90, v90, v217
  v_mul_f32 v91, v91, v217
  v_mul_f32 v92, v92, v217
  v_mul_f32 v93, v93, v217
  v_mul_f32 v94, v94, v217
  v_mul_f32 v95, v95, v217
  s_nop 1
  s_branch RET1
RARE1_7:
  s_nop 7
  s_nop 7
  v_mul_f32 v0, v0, v217
  v_mul_f32 v1, v1, v217
  v_mul_f32 v2, v2, v217
  v_mul_f32 v3, v3, v217
  v_mul_f32 v4, v4, v217
  v_mul_f32 v5, v5, v217
  v_mul_f32 v6, v6, v217
  v_mul_f32 v7, v7, v217
  v_mul_f32 v8, v8, v217
  v_mul_f32 v9, v9, v217
  v_mul_f32 v10, v10, v217
  v_mul_f32 v11, v11, v217
  v_mul_f32 v12, v12, v217
  v_mul_f32 v13, v13, v217
  v_mul_f32 v14, v14, v217
  v_mul_f32 v15, v15, v217
  v_mul_f32 v16, v16, v217
  v_mul_f32 v17, v17, v217
  v_mul_f32 v18, v18, v217
  v_mul_f32 v19, v19, v217
  v_mul_f32 v20, v20, v217
  v_mul_f32 v21, v21, v217
  v_mul_f32 v22, v22, v217
  v_mul_f32 v23, v23, v217
  v_mul_f32 v24, v24, v217
  v_mul_f32 v25, v25, v217
  v_mul_f32 v26, v26, v217
  v_mul_f32 v27, v27, v217
  v_mul_f32 v28, v28, v217
  v_mul_f32 v29, v29, v217
  v_mul_f32 v30, v30, v217
  v_mul_f32 v31, v31, v217
  v_mul_f32 v32, v32, v217
  v_mul_f32 v33, v33, v217
  v_mul_f32 v34, v34, v217
  v_mul_f32 v35, v35, v217
  v_mul_f32 v36, v36, v217
  v_mul_f32 v37, v37, v217
  v_mul_f32 v38, v38, v217
  v_mul_f32 v39, v39, v217
  v_mul_f32 v40, v40, v217
  v_mul_f32 v41, v41, v217
  v_mul_f32 v42, v42, v217
  v_mul_f32 v43, v43, v217
  v_mul_f32 v44, v44, v217
  v_mul_f32 v45, v45, v217
  v_mul_f32 v46, v46, v217
  v_mul_f32 v47, v47, v217
  v_mul_f32 v48, v48, v217
  v_mul_f32 v49, v49, v217
  v_mul_f32 v50, v50, v217
  v_mul_f32 v51, v51, v217
  v_mul_f32 v52, v52, v217
  v_mul_f32 v53, v53, v217
  v_mul_f32 v54, v54, v217
  v_mul_f32 v55, v55, v217
  v_mul_f32 v56, v56, v217
  v_mul_f32 v57, v57, v217
  v_mul_f32 v58, v58, v217
  v_mul_f32 v59, v59, v217
  v_mul_f32 v60, v60, v217
  v_mul_f32 v61, v61, v217
  v_mul_f32 v62, v62, v217
  v_mul_f32 v63, v63, v217
  v_mul_f32 v64, v64, v217
  v_mul_f32 v65, v65, v217
  v_mul_f32 v66, v66, v217
  v_mul_f32 v67, v67, v217
  v_mul_f32 v68, v68, v217
  v_mul_f32 v69, v69, v217
  v_mul_f32 v70, v70, v217
  v_mul_f32 v71, v71, v217
  v_mul_f32 v72, v72, v217
  v_mul_f32 v73, v73, v217
  v_mul_f32 v74, v74, v217
  v_mul_f32 v75, v75, v217
  v_mul_f32 v76, v76, v217
  v_mul_f32 v77, v77, v217
  v_mul_f32 v78, v78, v217
  v_mul_f32 v79, v79, v217
  v_mul_f32 v80, v80, v217
  v_mul_f32 v81, v81, v217
  v_mul_f32 v82, v82, v217
  v_mul_f32 v83, v83, v217
  v_mul_f32 v84, v84, v217
  v_mul_f32 v85, v85, v217
  v_mul_f32 v86, v86, v217
  v_mul_f32 v87, v87, v217
  v_mul_f32 v88, v88, v217
  v_mul_f32 v89, v89, v217
  v_mul_f32 v90, v90, v217
  v_mul_f32 v91, v91, v217
  v_mul_f32 v92, v92, v217
  v_mul_f32 v93, v93, v217
  v_mul_f32 v94, v94, v217
  v_mul_f32 v95, v95, v217
  s_nop 1
  s_branch RET1_7
XGA9:
  s_mov_b32 s8, s16
  s_mov_b32 s9, s17
  s_mov_b32 s10, s18
  s_mov_b32 s44, 0
  v_accvgpr_mov_b32 a144, a248
  v_accvgpr_mov_b32 a145, a249
  v_accvgpr_mov_b32 a146, a250
  v_accvgpr_mov_b32 a147, a251
  v_accvgpr_mov_b32 a148, a252
  v_accvgpr_mov_b32 a149, a253
  s_mov_b64 vcc, -1
  s_branch YGA9
XGB8:
  s_mov_b32 s4, s12
  s_mov_b32 s5, s13
  s_mov_b32 s6, s14
  s_mov_b32 s8, s12
  s_mov_b32 s9, s13
  s_mov_b32 s10, s14
  s_mov_b32 s56, 0
  s_mov_b32 s43, 24576
  v_accvgpr_read_b32 v192, a144
  v_accvgpr_read_b32 v198, a144
  v_accvgpr_read_b32 v193, a145
  v_accvgpr_read_b32 v199, a145
  v_accvgpr_read_b32 v194, a146
  v_accvgpr_read_b32 v240, a146
  v_accvgpr_read_b32 v195, a147
  v_accvgpr_read_b32 v241, a147
  v_accvgpr_read_b32 v196, a148
  v_accvgpr_read_b32 v242, a148
  v_accvgpr_read_b32 v197, a149
  v_accvgpr_read_b32 v243, a149
  s_branch YGB8
XGB9:
  s_mov_b32 s56, 49152
  s_mov_b32 s43, 24576
  s_mov_b32 s39, 122880
  s_branch YGB9
XGC0:
  v_cvt_pk_bf16_f32 v246, v0, v1
  v_accvgpr_write_b32 a0, v246
  v_cvt_pk_bf16_f32 v247, v2, v3
  v_accvgpr_write_b32 a1, v247
  v_cvt_pk_bf16_f32 v246, v4, v5
  v_accvgpr_write_b32 a2, v246
  v_cvt_pk_bf16_f32 v247, v6, v7
  v_accvgpr_write_b32 a3, v247
  v_cvt_pk_bf16_f32 v246, v8, v9
  v_accvgpr_write_b32 a4, v246
  v_cvt_pk_bf16_f32 v247, v10, v11
  v_accvgpr_write_b32 a5, v247
  v_cvt_pk_bf16_f32 v246, v12, v13
  v_accvgpr_write_b32 a6, v246
  v_cvt_pk_bf16_f32 v247, v14, v15
  v_accvgpr_write_b32 a7, v247
  s_branch YGC0
XGC1:
  v_cvt_pk_bf16_f32 v246, v16, v17
  v_accvgpr_write_b32 a8, v246
  v_cvt_pk_bf16_f32 v247, v18, v19
  v_accvgpr_write_b32 a9, v247
  v_cvt_pk_bf16_f32 v246, v20, v21
  v_accvgpr_write_b32 a10, v246
  v_cvt_pk_bf16_f32 v247, v22, v23
  v_accvgpr_write_b32 a11, v247
  v_cvt_pk_bf16_f32 v246, v24, v25
  v_accvgpr_write_b32 a12, v246
  v_cvt_pk_bf16_f32 v247, v26, v27
  v_accvgpr_write_b32 a13, v247
  v_cvt_pk_bf16_f32 v246, v28, v29
  v_accvgpr_write_b32 a14, v246
  v_cvt_pk_bf16_f32 v247, v30, v31
  v_accvgpr_write_b32 a15, v247
  s_branch YGC1
XGC2:
  v_cvt_pk_bf16_f32 v246, v32, v33
  v_accvgpr_write_b32 a16, v246
  v_cvt_pk_bf16_f32 v247, v34, v35
  v_accvgpr_write_b32 a17, v247
  v_cvt_pk_bf16_f32 v246, v36, v37
  v_accvgpr_write_b32 a18, v246
  v_cvt_pk_bf16_f32 v247, v38, v39
  v_accvgpr_write_b32 a19, v247
  v_cvt_pk_bf16_f32 v246, v40, v41
  v_accvgpr_write_b32 a20, v246
  v_cvt_pk_bf16_f32 v247, v42, v43
  v_accvgpr_write_b32 a21, v247
  v_cvt_pk_bf16_f32 v246, v44, v45
  v_accvgpr_write_b32 a22, v246
  v_cvt_pk_bf16_f32 v247, v46, v47
  v_accvgpr_write_b32 a23, v247
  s_branch YGC2
XGC3:
  v_cvt_pk_bf16_f32 v246, v48, v49
  v_accvgpr_write_b32 a24, v246
  v_cvt_pk_bf16_f32 v247, v50, v51
  v_accvgpr_write_b32 a25, v247
  v_cvt_pk_bf16_f32 v246, v52, v53
  v_accvgpr_write_b32 a26, v246
  v_cvt_pk_bf16_f32 v247, v54, v55
  v_accvgpr_write_b32 a27, v247
  v_cvt_pk_bf16_f32 v246, v56, v57
  v_accvgpr_write_b32 a28, v246
  v_cvt_pk_bf16_f32 v247, v58, v59
  v_accvgpr_write_b32 a29, v247
  v_cvt_pk_bf16_f32 v246, v60, v61
  v_accvgpr_write_b32 a30, v246
  v_cvt_pk_bf16_f32 v247, v62, v63
  v_accvgpr_write_b32 a31, v247
  s_branch YGC3
XGC4:
  v_cvt_pk_bf16_f32 v246, v64, v65
  v_accvgpr_write_b32 a32, v246
  v_cvt_pk_bf16_f32 v247, v66, v67
  v_accvgpr_write_b32 a33, v247
  v_cvt_pk_bf16_f32 v246, v68, v69
  v_accvgpr_write_b32 a34, v246
  v_cvt_pk_bf16_f32 v247, v70, v71
  v_accvgpr_write_b32 a35, v247
  v_cvt_pk_bf16_f32 v246, v72, v73
  v_accvgpr_write_b32 a36, v246
  v_cvt_pk_bf16_f32 v247, v74, v75
  v_accvgpr_write_b32 a37, v247
  v_cvt_pk_bf16_f32 v246, v76, v77
  v_accvgpr_write_b32 a38, v246
  v_cvt_pk_bf16_f32 v247, v78, v79
  v_accvgpr_write_b32 a39, v247
  s_branch YGC4
XGC5:
  v_cvt_pk_bf16_f32 v246, v80, v81
  v_accvgpr_write_b32 a40, v246
  v_cvt_pk_bf16_f32 v247, v82, v83
  v_accvgpr_write_b32 a41, v247
  v_cvt_pk_bf16_f32 v246, v84, v85
  v_accvgpr_write_b32 a42, v246
  v_cvt_pk_bf16_f32 v247, v86, v87
  v_accvgpr_write_b32 a43, v247
  v_cvt_pk_bf16_f32 v246, v88, v89
  v_accvgpr_write_b32 a44, v246
  v_cvt_pk_bf16_f32 v247, v90, v91
  v_accvgpr_write_b32 a45, v247
  v_cvt_pk_bf16_f32 v246, v92, v93
  v_accvgpr_write_b32 a46, v246
  v_cvt_pk_bf16_f32 v247, v94, v95
  v_accvgpr_write_b32 a47, v247
  s_branch YGC5
XGC6:
  v_accvgpr_read_b32 v250, a150
  v_accvgpr_read_b32 v251, a151
  v_accvgpr_read_b32 v252, a152
  v_accvgpr_read_b32 v253, a153
  v_cvt_pk_bf16_f32 v250, v250, v251
  v_cvt_pk_bf16_f32 v251, v252, v253
  ds_write_b64 v226, v[250:251] offset:0
  s_branch YGC6
XGC7:
  v_accvgpr_read_b32 v250, a154
  v_accvgpr_read_b32 v251, a155
  v_accvgpr_read_b32 v252, a156
  v_accvgpr_read_b32 v253, a157
  v_cvt_pk_bf16_f32 v250, v250, v251
  v_cvt_pk_bf16_f32 v251, v252, v253
  ds_write_b64 v226, v[250:251] offset:128
  s_branch YGC7
XGC8:
  v_accvgpr_read_b32 v250, a158
  v_accvgpr_read_b32 v251, a159
  v_accvgpr_read_b32 v252, a160
  v_accvgpr_read_b32 v253, a161
  v_cvt_pk_bf16_f32 v250, v250, v251
  v_cvt_pk_bf16_f32 v251, v252, v253
  ds_write_b64 v226, v[250:251] offset:256
  s_branch YGC8
XG40:
  s_mov_b32 s32, s16
  s_mov_b32 s33, s17
  s_mov_b32 s34, s18
  s_mov_b32 s44, 172032
  s_branch YG40
XG50:
  s_mov_b32 s28, s12
  s_mov_b32 s29, s13
  s_mov_b32 s30, s14
  s_mov_b32 s32, s12
  s_mov_b32 s33, s13
  s_mov_b32 s34, s14
  s_mov_b32 s43, 196608
  s_mov_b32 s44, 221184
  s_branch YG50
XG60:
  s_mov_b32 s28, s16
  s_mov_b32 s29, s17
  s_mov_b32 s30, s18
  s_mov_b32 s43, 196608
  s_mov_b32 s44, 245760
  s_branch YG60
XG41:
  s_mov_b32 s32, s16
  s_mov_b32 s33, s17
  s_mov_b32 s34, s18
  s_mov_b32 s44, 368640
  s_branch YG41
XG51:
  s_mov_b32 s28, s20
  s_mov_b32 s29, s21
  s_mov_b32 s30, s22
  s_mov_b32 s32, s20
  s_mov_b32 s33, s21
  s_mov_b32 s34, s22
  s_mov_b32 s43, 0
  s_mov_b32 s44, 122880
  v_accvgpr_read_b32 v192, a144
  v_accvgpr_read_b32 v193, a145
  v_accvgpr_read_b32 v194, a146
  v_accvgpr_read_b32 v195, a147
  v_accvgpr_read_b32 v196, a148
  v_accvgpr_read_b32 v197, a149
  s_add_u32 s46, s93, 12288
  buffer_load_dword v255, v254, s[20:23], s46 offen
  s_add_u32 s46, s93, 24576
  buffer_load_dword v255, v254, s[20:23], s46 offen
  s_add_u32 s46, s93, 36864
  buffer_load_dword v255, v254, s[20:23], s46 offen
  s_branch YG51
XG61:
  s_mov_b32 s28, s20
  s_mov_b32 s29, s21
  s_mov_b32 s30, s22
  s_mov_b32 s43, 245760
  s_mov_b32 s44, 368640
  s_add_u32 s46, s93, 49152
  buffer_load_dword v255, v254, s[20:23], s46 offen
  s_add_u32 s46, s93, 61440
  buffer_load_dword v255, v254, s[20:23], s46 offen
  s_branch YG61
.globl reduce_kernel
.p2align 8
.type reduce_kernel,@function
reduce_kernel:
  s_cmp_ge_u32 s2, 720
  s_cbranch_scc1 K2END
  s_load_dwordx2 s[4:5], s[0:1], 96
  s_load_dwordx2 s[6:7], s[0:1], 80
  v_lshrrev_b32 v1, 6, v0
  s_nop 0
  v_readfirstlane_b32 s3, v1
  v_and_b32 v0, 63, v0
  s_lshl_b32 s16, s2, 2
  s_add_u32 s16, s16, s3
  s_mul_i32 s17, s16, 5826
  s_lshr_b32 s17, s17, 20
  s_mul_i32 s18, s17, 180
  s_sub_u32 s18, s16, s18
  s_mul_i32 s19, s18, 1821
  s_lshr_b32 s19, s19, 16
  s_mul_i32 s20, s19, 36
  s_sub_u32 s20, s18, s20
  s_lshl_b32 s21, s18, 10
  v_lshlrev_b32 v1, 4, v0
  v_add_u32 v1, s21, v1
  s_mul_i32 s22, s17, 2949120
  s_waitcnt lgkmcnt(0)
  s_add_u32 s8, s4, s22
  s_addc_u32 s9, s5, 0
  s_mov_b32 s10, 2949120
  s_mov_b32 s11, 0x20000
  s_mov_b32 s12, s6
  s_mov_b32 s13, s7
  s_mov_b32 s14, 2949120
  s_mov_b32 s15, 0x20000
  s_mov_b32 s23, 0
  buffer_load_dwordx4 v[8:11], v1, s[8:11], s23 offen
  s_add_u32 s23, s23, 184320
  buffer_load_dwordx4 v[12:15], v1, s[8:11], s23 offen
  s_add_u32 s23, s23, 184320
  buffer_load_dwordx4 v[16:19], v1, s[8:11], s23 offen
  s_add_u32 s23, s23, 184320
  buffer_load_dwordx4 v[20:23], v1, s[8:11], s23 offen
  s_add_u32 s23, s23, 184320
  buffer_load_dwordx4 v[24:27], v1, s[8:11], s23 offen
  s_add_u32 s23, s23, 184320
  buffer_load_dwordx4 v[28:31], v1, s[8:11], s23 offen
  s_add_u32 s23, s23, 184320
  buffer_load_dwordx4 v[32:35], v1, s[8:11], s23 offen
  s_add_u32 s23, s23, 184320
  buffer_load_dwordx4 v[36:39], v1, s[8:11], s23 offen
  s_add_u32 s23, s23, 184320
  buffer_load_dwordx4 v[40:43], v1, s[8:11], s23 offen
  s_add_u32 s23, s23, 184320
  buffer_load_dwordx4 v[44:47], v1, s[8:11], s23 offen
  s_add_u32 s23, s23, 184320
  buffer_load_dwordx4 v[48:51], v1, s[8:11], s23 offen
  s_add_u32 s23, s23, 184320
  buffer_load_dwordx4 v[52:55], v1, s[8:11], s23 offen
  s_add_u32 s23, s23, 184320
  buffer_load_dwordx4 v[56:59], v1, s[8:11], s23 offen
  s_add_u32 s23, s23, 184320
  buffer_load_dwordx4 v[60:63], v1, s[8:11], s23 offen
  s_add_u32 s23, s23, 184320
  buffer_load_dwordx4 v[64:67], v1, s[8:11], s23 offen
  s_add_u32 s23, s23, 184320
  buffer_load_dwordx4 v[68:71], v1, s[8:11], s23 offen
  s_add_u32 s23, s23, 184320
  s_and_b32 s24, s17, 7
  s_mul_i32 s24, s24, 368640
  s_lshr_b32 s25, s17, 3
  s_mul_i32 s25, s25, 1280
  s_add_u32 s24, s24, s25
  s_lshl_b32 s25, s19, 8
  s_add_u32 s24, s24, s25
  s_cmp_ge_u32 s20, 32
  s_cbranch_scc1 K2L
  s_lshr_b32 s25, s20, 3
  s_mul_i32 s25, s25, 81920
  s_add_u32 s24, s24, s25
  s_and_b32 s25, s20, 7
  s_lshl_b32 s25, s25, 4
  s_add_u32 s24, s24, s25
  v_and_b32 v2, 31, v0
  v_mul_u32_u24 v2, 2560, v2
  v_lshrrev_b32 v3, 5, v0
  v_lshl_add_u32 v2, v3, 7, v2
  s_branch K2S
K2L:
  s_sub_u32 s25, s20, 32
  s_lshl_b32 s25, s25, 6
  s_add_u32 s24, s24, s25
  s_add_u32 s24, s24, 327680
  v_and_b32 v2, 15, v0
  v_mul_u32_u24 v2, 2560, v2
  v_lshrrev_b32 v3, 4, v0
  v_lshl_add_u32 v2, v3, 4, v2
K2S:
  s_mov_b32 s26, 0xffff0000
  s_waitcnt vmcnt(15)
  v_lshlrev_b32 v72, 16, v8
  v_and_b32 v73, s26, v8
  v_lshlrev_b32 v74, 16, v9
  v_and_b32 v75, s26, v9
  v_lshlrev_b32 v76, 16, v10
  v_and_b32 v77, s26, v10
  v_lshlrev_b32 v78, 16, v11
  v_and_b32 v79, s26, v11
  s_waitcnt vmcnt(14)
  v_lshlrev_b32 v4, 16, v12
  v_and_b32 v5, s26, v12
  v_add_f32 v72, v72, v4
  v_add_f32 v73, v73, v5
  v_lshlrev_b32 v4, 16, v13
  v_and_b32 v5, s26, v13
  v_add_f32 v74, v74, v4
  v_add_f32 v75, v75, v5
  v_lshlrev_b32 v4, 16, v14
  v_and_b32 v5, s26, v14
  v_add_f32 v76, v76, v4
  v_add_f32 v77, v77, v5
  v_lshlrev_b32 v4, 16, v15
  v_and_b32 v5, s26, v15
  v_add_f32 v78, v78, v4
  v_add_f32 v79, v79, v5
  s_waitcnt vmcnt(13)
  v_lshlrev_b32 v4, 16, v16
  v_and_b32 v5, s26, v16
  v_add_f32 v72, v72, v4
  v_add_f32 v73, v73, v5
  v_lshlrev_b32 v4, 16, v17
  v_and_b32 v5, s26, v17
  v_add_f32 v74, v74, v4
  v_add_f32 v75, v75, v5
  v_lshlrev_b32 v4, 16, v18
  v_and_b32 v5, s26, v18
  v_add_f32 v76, v76, v4
  v_add_f32 v77, v77, v5
  v_lshlrev_b32 v4, 16, v19
  v_and_b32 v5, s26, v19
  v_add_f32 v78, v78, v4
  v_add_f32 v79, v79, v5
  s_waitcnt vmcnt(12)
  v_lshlrev_b32 v4, 16, v20
  v_and_b32 v5, s26, v20
  v_add_f32 v72, v72, v4
  v_add_f32 v73, v73, v5
  v_lshlrev_b32 v4, 16, v21
  v_and_b32 v5, s26, v21
  v_add_f32 v74, v74, v4
  v_add_f32 v75, v75, v5
  v_lshlrev_b32 v4, 16, v22
  v_and_b32 v5, s26, v22
  v_add_f32 v76, v76, v4
  v_add_f32 v77, v77, v5
  v_lshlrev_b32 v4, 16, v23
  v_and_b32 v5, s26, v23
  v_add_f32 v78, v78, v4
  v_add_f32 v79, v79, v5
  s_waitcnt vmcnt(11)
  v_lshlrev_b32 v4, 16, v24
  v_and_b32 v5, s26, v24
  v_add_f32 v72, v72, v4
  v_add_f32 v73, v73, v5
  v_lshlrev_b32 v4, 16, v25
  v_and_b32 v5, s26, v25
  v_add_f32 v74, v74, v4
  v_add_f32 v75, v75, v5
  v_lshlrev_b32 v4, 16, v26
  v_and_b32 v5, s26, v26
  v_add_f32 v76, v76, v4
  v_add_f32 v77, v77, v5
  v_lshlrev_b32 v4, 16, v27
  v_and_b32 v5, s26, v27
  v_add_f32 v78, v78, v4
  v_add_f32 v79, v79, v5
  s_waitcnt vmcnt(10)
  v_lshlrev_b32 v4, 16, v28
  v_and_b32 v5, s26, v28
  v_add_f32 v72, v72, v4
  v_add_f32 v73, v73, v5
  v_lshlrev_b32 v4, 16, v29
  v_and_b32 v5, s26, v29
  v_add_f32 v74, v74, v4
  v_add_f32 v75, v75, v5
  v_lshlrev_b32 v4, 16, v30
  v_and_b32 v5, s26, v30
  v_add_f32 v76, v76, v4
  v_add_f32 v77, v77, v5
  v_lshlrev_b32 v4, 16, v31
  v_and_b32 v5, s26, v31
  v_add_f32 v78, v78, v4
  v_add_f32 v79, v79, v5
  s_waitcnt vmcnt(9)
  v_lshlrev_b32 v4, 16, v32
  v_and_b32 v5, s26, v32
  v_add_f32 v72, v72, v4
  v_add_f32 v73, v73, v5
  v_lshlrev_b32 v4, 16, v33
  v_and_b32 v5, s26, v33
  v_add_f32 v74, v74, v4
  v_add_f32 v75, v75, v5
  v_lshlrev_b32 v4, 16, v34
  v_and_b32 v5, s26, v34
  v_add_f32 v76, v76, v4
  v_add_f32 v77, v77, v5
  v_lshlrev_b32 v4, 16, v35
  v_and_b32 v5, s26, v35
  v_add_f32 v78, v78, v4
  v_add_f32 v79, v79, v5
  s_waitcnt vmcnt(8)
  v_lshlrev_b32 v4, 16, v36
  v_and_b32 v5, s26, v36
  v_add_f32 v72, v72, v4
  v_add_f32 v73, v73, v5
  v_lshlrev_b32 v4, 16, v37
  v_and_b32 v5, s26, v37
  v_add_f32 v74, v74, v4
  v_add_f32 v75, v75, v5
  v_lshlrev_b32 v4, 16, v38
  v_and_b32 v5, s26, v38
  v_add_f32 v76, v76, v4
  v_add_f32 v77, v77, v5
  v_lshlrev_b32 v4, 16, v39
  v_and_b32 v5, s26, v39
  v_add_f32 v78, v78, v4
  v_add_f32 v79, v79, v5
  s_waitcnt vmcnt(7)
  v_lshlrev_b32 v4, 16, v40
  v_and_b32 v5, s26, v40
  v_add_f32 v72, v72, v4
  v_add_f32 v73, v73, v5
  v_lshlrev_b32 v4, 16, v41
  v_and_b32 v5, s26, v41
  v_add_f32 v74, v74, v4
  v_add_f32 v75, v75, v5
  v_lshlrev_b32 v4, 16, v42
  v_and_b32 v5, s26, v42
  v_add_f32 v76, v76, v4
  v_add_f32 v77, v77, v5
  v_lshlrev_b32 v4, 16, v43
  v_and_b32 v5, s26, v43
  v_add_f32 v78, v78, v4
  v_add_f32 v79, v79, v5
  s_waitcnt vmcnt(6)
  v_lshlrev_b32 v4, 16, v44
  v_and_b32 v5, s26, v44
  v_add_f32 v72, v72, v4
  v_add_f32 v73, v73, v5
  v_lshlrev_b32 v4, 16, v45
  v_and_b32 v5, s26, v45
  v_add_f32 v74, v74, v4
  v_add_f32 v75, v75, v5
  v_lshlrev_b32 v4, 16, v46
  v_and_b32 v5, s26, v46
  v_add_f32 v76, v76, v4
  v_add_f32 v77, v77, v5
  v_lshlrev_b32 v4, 16, v47
  v_and_b32 v5, s26, v47
  v_add_f32 v78, v78, v4
  v_add_f32 v79, v79, v5
  s_waitcnt vmcnt(5)
  v_lshlrev_b32 v4, 16, v48
  v_and_b32 v5, s26, v48
  v_add_f32 v72, v72, v4
  v_add_f32 v73, v73, v5
  v_lshlrev_b32 v4, 16, v49
  v_and_b32 v5, s26, v49
  v_add_f32 v74, v74, v4
  v_add_f32 v75, v75, v5
  v_lshlrev_b32 v4, 16, v50
  v_and_b32 v5, s26, v50
  v_add_f32 v76, v76, v4
  v_add_f32 v77, v77, v5
  v_lshlrev_b32 v4, 16, v51
  v_and_b32 v5, s26, v51
  v_add_f32 v78, v78, v4
  v_add_f32 v79, v79, v5
  s_waitcnt vmcnt(4)
  v_lshlrev_b32 v4, 16, v52
  v_and_b32 v5, s26, v52
  v_add_f32 v72, v72, v4
  v_add_f32 v73, v73, v5
  v_lshlrev_b32 v4, 16, v53
  v_and_b32 v5, s26, v53
  v_add_f32 v74, v74, v4
  v_add_f32 v75, v75, v5
  v_lshlrev_b32 v4, 16, v54
  v_and_b32 v5, s26, v54
  v_add_f32 v76, v76, v4
  v_add_f32 v77, v77, v5
  v_lshlrev_b32 v4, 16, v55
  v_and_b32 v5, s26, v55
  v_add_f32 v78, v78, v4
  v_add_f32 v79, v79, v5
  s_waitcnt vmcnt(3)
  v_lshlrev_b32 v4, 16, v56
  v_and_b32 v5, s26, v56
  v_add_f32 v72, v72, v4
  v_add_f32 v73, v73, v5
  v_lshlrev_b32 v4, 16, v57
  v_and_b32 v5, s26, v57
  v_add_f32 v74, v74, v4
  v_add_f32 v75, v75, v5
  v_lshlrev_b32 v4, 16, v58
  v_and_b32 v5, s26, v58
  v_add_f32 v76, v76, v4
  v_add_f32 v77, v77, v5
  v_lshlrev_b32 v4, 16, v59
  v_and_b32 v5, s26, v59
  v_add_f32 v78, v78, v4
  v_add_f32 v79, v79, v5
  s_waitcnt vmcnt(2)
  v_lshlrev_b32 v4, 16, v60
  v_and_b32 v5, s26, v60
  v_add_f32 v72, v72, v4
  v_add_f32 v73, v73, v5
  v_lshlrev_b32 v4, 16, v61
  v_and_b32 v5, s26, v61
  v_add_f32 v74, v74, v4
  v_add_f32 v75, v75, v5
  v_lshlrev_b32 v4, 16, v62
  v_and_b32 v5, s26, v62
  v_add_f32 v76, v76, v4
  v_add_f32 v77, v77, v5
  v_lshlrev_b32 v4, 16, v63
  v_and_b32 v5, s26, v63
  v_add_f32 v78, v78, v4
  v_add_f32 v79, v79, v5
  s_waitcnt vmcnt(1)
  v_lshlrev_b32 v4, 16, v64
  v_and_b32 v5, s26, v64
  v_add_f32 v72, v72, v4
  v_add_f32 v73, v73, v5
  v_lshlrev_b32 v4, 16, v65
  v_and_b32 v5, s26, v65
  v_add_f32 v74, v74, v4
  v_add_f32 v75, v75, v5
  v_lshlrev_b32 v4, 16, v66
  v_and_b32 v5, s26, v66
  v_add_f32 v76, v76, v4
  v_add_f32 v77, v77, v5
  v_lshlrev_b32 v4, 16, v67
  v_and_b32 v5, s26, v67
  v_add_f32 v78, v78, v4
  v_add_f32 v79, v79, v5
  s_waitcnt vmcnt(0)
  v_lshlrev_b32 v4, 16, v68
  v_and_b32 v5, s26, v68
  v_add_f32 v72, v72, v4
  v_add_f32 v73, v73, v5
  v_lshlrev_b32 v4, 16, v69
  v_and_b32 v5, s26, v69
  v_add_f32 v74, v74, v4
  v_add_f32 v75, v75, v5
  v_lshlrev_b32 v4, 16, v70
  v_and_b32 v5, s26, v70
  v_add_f32 v76, v76, v4
  v_add_f32 v77, v77, v5
  v_lshlrev_b32 v4, 16, v71
  v_and_b32 v5, s26, v71
  v_add_f32 v78, v78, v4
  v_add_f32 v79, v79, v5
  v_cvt_pk_bf16_f32 v4, v72, v73
  v_cvt_pk_bf16_f32 v5, v74, v75
  v_cvt_pk_bf16_f32 v6, v76, v77
  v_cvt_pk_bf16_f32 v7, v78, v79
  buffer_store_dwordx4 v[4:7], v2, s[12:15], s24 offen
  s_waitcnt vmcnt(0)
K2END:
  s_endpgm
.section .rodata,"a"
.p2align 6
.amdhsa_kernel concat_heads__gqa_block_cached__gqa_block_cached__near_ridge_kernel
  .amdhsa_next_free_vgpr 512
  .amdhsa_next_free_sgpr 102
  .amdhsa_accum_offset 256
  .amdhsa_group_segment_fixed_size 0
  .amdhsa_kernarg_size 104
  .amdhsa_user_sgpr_count 2
  .amdhsa_user_sgpr_kernarg_segment_ptr 1
  .amdhsa_system_sgpr_workgroup_id_x 1
.end_amdhsa_kernel
.p2align 6
.amdhsa_kernel reduce_kernel
  .amdhsa_next_free_vgpr 80
  .amdhsa_next_free_sgpr 102
  .amdhsa_accum_offset 80
  .amdhsa_group_segment_fixed_size 0
  .amdhsa_kernarg_size 104
  .amdhsa_user_sgpr_count 2
  .amdhsa_user_sgpr_kernarg_segment_ptr 1
  .amdhsa_system_sgpr_workgroup_id_x 1
.end_amdhsa_kernel
```
